```python
import torch

def _softmax(x, axis=-1):
    return torch.softmax(x, dim=axis)

def _gelu(x):
    return torch.nn.functional.gelu(x, approximate='tanh')

def _silu(x):
    return torch.nn.functional.silu(x)

def _sigmoid(x):
    return torch.sigmoid(x)

def _layernorm(x, axis=-1, eps=1e-05):
    m = x.mean(dim=axis, keepdim=True)
    v = x.var(dim=axis, keepdim=True, unbiased=False)
    return (x - m) / torch.sqrt(v + eps)

def _scatter_add(tgt, idx, src, axis=0):
    return tgt.clone().index_add_(axis, idx, src)

def _segment_sum(src, seg, n):
    out = torch.zeros((n,) + src.shape[1:], dtype=src.dtype)
    return out.index_add_(0, seg, src)

def _pad(x, pw):
    flat = tuple((v for pair in reversed(pw) for v in pair))
    return torch.nn.functional.pad(x, flat)
kernel_name = 'adaLN_cond__gqa_block_cached__swiglu_ffn__decode'

def setup_inputs():

    _w = lambda a: (lambda t: t.to(torch.bfloat16) if t.is_floating_point() else t)(torch.as_tensor(a))

    def _A_setup():
        B, Sq, D = (1, 1, 640)
        Hq, Hkv, Sk, Dh = (32, 32, 8192, 128)
        assert Hq % Hkv == 0, (Hq, Hkv)
        return {'x': _w((lambda *s: torch.randn(*s, dtype=torch.bfloat16) * 0.05)(B, Sq, D)), 'k_cache': _w((lambda *s: torch.randn(*s, dtype=torch.bfloat16) * 3.2)(B, Hkv, Sk, Dh)), 'v_cache': _w((lambda *s: torch.randn(*s, dtype=torch.bfloat16) * 0.4)(B, Hkv, Sk, Dh)), 'wq': _w((lambda *s: torch.randn(*s, dtype=torch.bfloat16) * 3.2)(D, Hq * Dh) * D ** (-0.5)), 'wo': _w((lambda *s: torch.randn(*s, dtype=torch.bfloat16) * 0.4)(Hq * Dh, D) * (Hq * Dh) ** (-0.5))}
    _A_in = _A_setup()

    def _B_setup():
        B, S, D, F = (1, 1, 640, 1728)
        return {'x': _w((lambda *s: torch.randn(*s, dtype=torch.bfloat16) * 0.05)(B, S, D)), 'w_gate': _w((lambda *s: torch.randn(*s, dtype=torch.bfloat16) * 0.05)(D, F)), 'w_up': _w((lambda *s: torch.randn(*s, dtype=torch.bfloat16) * 0.05)(D, F)), 'w_down': _w((lambda *s: torch.randn(*s, dtype=torch.bfloat16) * 0.05)(F, D))}
    _B_in = _B_setup()
    return {'A_x': _A_in['x'], 'A_k_cache': _A_in['k_cache'], 'A_v_cache': _A_in['v_cache'], 'A_wq': _A_in['wq'], 'A_wo': _A_in['wo'], 'B_x': _B_in['x'], 'B_w_gate': _B_in['w_gate'], 'B_w_up': _B_in['w_up'], 'B_w_down': _B_in['w_down'], 'c': _w((lambda *s: torch.randn(*s, dtype=torch.bfloat16) * 0.1)(1, 640) * 8.0), 'w_mod': _w((lambda *s: torch.randn(*s, dtype=torch.bfloat16) * 0.1)(640, 6 * 640) * 640 ** (-0.5) * 8.0)}

def reference(A_x, A_k_cache, A_v_cache, A_wq, A_wo, B_x, B_w_gate, B_w_up, B_w_down, c, w_mod):

    def _A_ref(x, k_cache, v_cache, wq, wo):
        B, Sq, D = x.shape
        Hq, Dh = (32, 128)
        Hkv = k_cache.shape[1]
        rep = Hq // Hkv
        q = (lambda x, *d: x.permute(*d))((x @ wq).reshape(B, Sq, Hq, Dh), 0, 2, 1, 3)
        k = (lambda x, n, axis: torch.repeat_interleave(x, n, dim=axis))(k_cache, rep, axis=1)
        v = (lambda x, n, axis: torch.repeat_interleave(x, n, dim=axis))(v_cache, rep, axis=1)
        scores = torch.einsum('bhqd,bhkd->bhqk', q, k) * Dh ** (-0.5)
        p = _softmax(scores, axis=-1)
        o = torch.einsum('bhqk,bhkd->bhqd', p, v)
        return (lambda x, *d: x.permute(*d))(o, 0, 2, 1, 3).reshape(B, Sq, Hq * Dh) @ wo

    def _B_ref(x, w_gate, w_up, w_down):
        g = _silu(x @ w_gate)
        u = x @ w_up
        return g * u @ w_down
    x = A_x
    mod = (_silu(c) @ w_mod).reshape(c.shape[0], 6, 1, -1)
    sa, ca, ga, sb, cb, gb = (mod[:, 0].clone(), mod[:, 1].clone(), mod[:, 2].clone(), mod[:, 3].clone(), mod[:, 4].clone(), mod[:, 5].clone())
    h = _layernorm(x, axis=-1) * (1 + ca) + sa
    x = x + ga * _A_ref(h, A_k_cache, A_v_cache, A_wq, A_wo)
    h = _layernorm(x, axis=-1) * (1 + cb) + sb
    x = x + gb * _B_ref(h, B_w_gate, B_w_up, B_w_down)
    return x
```

```asm
; @launch grid=(256,1,1) block=(768,1,1) lds=157696
.amdgcn_target "amdgcn-amd-amdhsa--gfx950"
.text
.globl adaLN_cond__gqa_block_cached__swiglu_ffn__decode_kernel
.p2align 8
.type adaLN_cond__gqa_block_cached__swiglu_ffn__decode_kernel,@function
adaLN_cond__gqa_block_cached__swiglu_ffn__decode_kernel:
  s_load_dwordx16 s[36:51], s[0:1], 0
  s_load_dwordx8 s[52:59], s[0:1], 64
  s_load_dwordx4 s[60:63], s[0:1], 96
  v_lshrrev_b32 v1, 6, v0
  v_and_b32 v0, 63, v0
  v_readfirstlane_b32 s3, v1
  s_cmp_lt_u32 s2, 256
  s_nop 2
  s_cbranch_scc1 L_in
  s_endpgm
L_in:
  v_and_b32 v1, 15, v0
  v_lshrrev_b32 v2, 4, v0
  s_lshr_b32 s5, s2, 3
  s_and_b32 s7, s2, 7
  s_add_u32 s6, s7, s5
  s_bfe_u32 s4, s6, 0x10002
  s_and_b32 s6, s6, 3
  s_lshl_b32 s6, s6, 1
  s_or_b32 s6, s6, s4
  s_cmp_ge_u32 s3, 4
  s_cbranch_scc1 L_stream
  s_getpc_b64 s[16:17]
L_pc:
  s_sub_u32 s16, s16, L_pc-adaLN_cond__gqa_block_cached__swiglu_ffn__decode_kernel
  s_subb_u32 s17, s17, 0
  s_lshl_b32 s18, s5, 2
  s_add_u32 s18, s18, s3
  s_lshl_b32 s18, s18, 9
  v_lshl_add_u32 v3, v0, 6, s18
  v_min_u32 v3, L_end-adaLN_cond__gqa_block_cached__swiglu_ffn__decode_kernel, v3
  s_mov_b64 exec, 0xff
  global_load_dword v167, v3, s[16:17]
  s_mov_b64 exec, -1
  v_lshlrev_b32 v10, 3, v0
  v_mov_b32 v8, 0
  v_mov_b32 v9, 0
  ds_write_b64 v10, v[8:9] offset:5632
  ds_write_b64 v10, v[8:9]
  s_waitcnt lgkmcnt(0)
  s_load_dword s32, s[62:63], 327680
  s_barrier
  s_branch L_help
L_stream:
  s_sub_u32 s3, s3, 4
  v_lshlrev_b32 v3, 6, v1
  v_lshl_add_u32 v3, v2, 4, v3
  s_lshl_b32 s33, s5, 21
  s_lshl_b32 s17, s3, 10
  s_add_u32 s33, s33, s17
  s_mul_i32 s16, s6, 180224
  s_add_u32 s16, s16, s33
  s_mov_b32 s10, 0x4000000
  s_mov_b32 s11, 0x20000
  s_waitcnt lgkmcnt(0)
  s_mov_b32 s8, s38
  s_and_b32 s9, s39, 0xffff
  s_mov_b32 s17, s16
  buffer_load_dwordx4 v[40:43], v3, s[8:11], s17 offen nt
  s_add_u32 s17, s17, 8192
  buffer_load_dwordx4 v[44:47], v3, s[8:11], s17 offen nt
  s_add_u32 s17, s17, 8192
  buffer_load_dwordx4 v[48:51], v3, s[8:11], s17 offen nt
  s_add_u32 s33, s33, 1441792
  s_mov_b32 s12, s40
  s_and_b32 s13, s41, 0xffff
  s_mov_b32 s14, 67108864
  s_mov_b32 s15, 0x20000
  s_barrier
  v_and_b32 v4, 3, v1
  v_lshlrev_b32 v4, 6, v4
  v_lshl_add_u32 v4, v2, 4, v4
  v_lshlrev_b32 v14, 5, v1
  v_lshl_add_u32 v14, v2, 4, v14
  s_lshl_b32 s18, s3, 9
  v_add_u32 v14, s18, v14
  v_lshlrev_b32 v2, 4, v0
  v_lshlrev_b32 v1, 2, v0
  v_mov_b32 v6, 0
  v_writelane_b32 v6, 3, 0
  ds_add_u32 v1, v6 offset:0
  v_writelane_b32 v6, 1, 0
  s_mov_b32 s20, 572662306
  s_mov_b32 s21, 572662306
  s_mov_b32 s22, 1145324612
  s_mov_b32 s23, 1145324612
  s_mov_b32 s24, 2290649224
  s_mov_b32 s25, 2290649224
  s_mov_b32 s26, 2863311530
  s_mov_b32 s27, 2863311530
  s_mov_b32 s28, 3435973836
  s_mov_b32 s29, 3435973836
  s_mov_b32 s66, 983055
  s_mov_b32 s67, 983055
  s_mov_b32 s68, 15728880
  s_mov_b32 s69, 15728880
  s_mov_b32 s70, 251662080
  s_mov_b32 s71, 251662080
  s_mov_b32 s72, 4026593280
  s_mov_b32 s73, 4026593280
  s_lshl_b32 s18, s3, 3
  v_mov_b32 v15, s18
  s_lshl_b32 s18, s5, 14
  s_lshl_b32 s19, s6, 9
  s_add_u32 s18, s18, s19
  s_and_b32 s19, s5, 1
  s_lshl_b32 s19, s19, 12
  s_sub_u32 s18, s18, s19
  s_add_u32 s64, s18, 786432
  s_add_u32 s64, s62, s64
  s_addc_u32 s65, s63, 0
  s_lshl_b32 s18, s5, 11
  s_lshl_b32 s19, s6, 7
  s_add_u32 s18, s18, s19
  s_add_u32 s30, s18, 262144
  s_add_u32 s30, s62, s30
  s_addc_u32 s31, s63, 0
  s_add_u32 s17, s17, 8192
  s_waitcnt vmcnt(2)
  buffer_load_dwordx4 v[52:55], v3, s[8:11], s17 offen nt
  ds_add_rtn_u32 v7, v1, v6 offset:0
  s_add_u32 s17, s17, 8192
  s_waitcnt vmcnt(4) lgkmcnt(0)
  v_readfirstlane_b32 s19, v7
  s_nop 0
  s_cmp_ge_i32 s19, 40
  s_cbranch_scc1 Lgo_1
  s_waitcnt vmcnt(3)
  s_cmp_ge_i32 s19, 32
  s_cbranch_scc1 Lgo_1
  s_waitcnt vmcnt(2)
  s_cmp_ge_i32 s19, 24
  s_cbranch_scc1 Lgo_1
  s_waitcnt vmcnt(1)
Lgo_1:
  buffer_load_dwordx4 v[56:59], v3, s[8:11], s17 offen nt
  ds_add_rtn_u32 v7, v1, v6 offset:0
  s_add_u32 s17, s17, 8192
  s_waitcnt vmcnt(4) lgkmcnt(0)
  v_readfirstlane_b32 s19, v7
  s_nop 0
  s_cmp_ge_i32 s19, 44
  s_cbranch_scc1 Lgo_2
  s_waitcnt vmcnt(3)
  s_cmp_ge_i32 s19, 36
  s_cbranch_scc1 Lgo_2
  s_waitcnt vmcnt(2)
  s_cmp_ge_i32 s19, 28
  s_cbranch_scc1 Lgo_2
  s_waitcnt vmcnt(1)
Lgo_2:
  buffer_load_dwordx4 v[60:63], v3, s[8:11], s17 offen nt
  ds_add_rtn_u32 v7, v1, v6 offset:0
  s_add_u32 s17, s17, 8192
  s_waitcnt vmcnt(4) lgkmcnt(0)
  v_readfirstlane_b32 s19, v7
  s_nop 0
  s_cmp_ge_i32 s19, 54
  s_cbranch_scc1 Lgo_3
  s_waitcnt vmcnt(3)
  s_cmp_ge_i32 s19, 46
  s_cbranch_scc1 Lgo_3
  s_waitcnt vmcnt(2)
  s_cmp_ge_i32 s19, 38
  s_cbranch_scc1 Lgo_3
  s_waitcnt vmcnt(1)
Lgo_3:
  buffer_load_dwordx4 v[64:67], v3, s[8:11], s17 offen nt
  ds_add_rtn_u32 v7, v1, v6 offset:0
  s_add_u32 s17, s17, 8192
  s_waitcnt vmcnt(4) lgkmcnt(0)
  v_readfirstlane_b32 s19, v7
  s_nop 0
  s_cmp_ge_i32 s19, 58
  s_cbranch_scc1 Lgo_4
  s_waitcnt vmcnt(3)
  s_cmp_ge_i32 s19, 50
  s_cbranch_scc1 Lgo_4
  s_waitcnt vmcnt(2)
  s_cmp_ge_i32 s19, 42
  s_cbranch_scc1 Lgo_4
  s_waitcnt vmcnt(1)
Lgo_4:
  buffer_load_dwordx4 v[68:71], v3, s[8:11], s17 offen nt
  ds_add_rtn_u32 v7, v1, v6 offset:0
  s_add_u32 s17, s17, 8192
  s_waitcnt vmcnt(4) lgkmcnt(0)
  v_readfirstlane_b32 s19, v7
  s_nop 0
  s_cmp_ge_i32 s19, 72
  s_cbranch_scc1 Lgo_5
  s_waitcnt vmcnt(3)
  s_cmp_ge_i32 s19, 64
  s_cbranch_scc1 Lgo_5
  s_waitcnt vmcnt(2)
  s_cmp_ge_i32 s19, 56
  s_cbranch_scc1 Lgo_5
  s_waitcnt vmcnt(1)
Lgo_5:
  buffer_load_dwordx4 v[72:75], v3, s[8:11], s17 offen nt
  ds_add_rtn_u32 v7, v1, v6 offset:0
  s_add_u32 s17, s17, 8192
  s_waitcnt vmcnt(4) lgkmcnt(0)
  v_readfirstlane_b32 s19, v7
  s_nop 0
  s_cmp_ge_i32 s19, 76
  s_cbranch_scc1 Lgo_6
  s_waitcnt vmcnt(3)
  s_cmp_ge_i32 s19, 68
  s_cbranch_scc1 Lgo_6
  s_waitcnt vmcnt(2)
  s_cmp_ge_i32 s19, 60
  s_cbranch_scc1 Lgo_6
  s_waitcnt vmcnt(1)
Lgo_6:
  buffer_load_dwordx4 v[76:79], v3, s[8:11], s17 offen nt
  ds_add_rtn_u32 v7, v1, v6 offset:0
  s_add_u32 s17, s17, 8192
  s_waitcnt vmcnt(4) lgkmcnt(0)
  v_readfirstlane_b32 s19, v7
  s_nop 0
  s_cmp_ge_i32 s19, 86
  s_cbranch_scc1 Lgo_7
  s_waitcnt vmcnt(3)
  s_cmp_ge_i32 s19, 78
  s_cbranch_scc1 Lgo_7
  s_waitcnt vmcnt(2)
  s_cmp_ge_i32 s19, 70
  s_cbranch_scc1 Lgo_7
  s_waitcnt vmcnt(1)
Lgo_7:
  buffer_load_dwordx4 v[80:83], v3, s[8:11], s17 offen nt
  ds_add_rtn_u32 v7, v1, v6 offset:0
  s_add_u32 s17, s17, 8192
  s_waitcnt vmcnt(4) lgkmcnt(0)
  v_readfirstlane_b32 s19, v7
  s_nop 0
  s_cmp_ge_i32 s19, 90
  s_cbranch_scc1 Lgo_8
  s_waitcnt vmcnt(3)
  s_cmp_ge_i32 s19, 82
  s_cbranch_scc1 Lgo_8
  s_waitcnt vmcnt(2)
  s_cmp_ge_i32 s19, 74
  s_cbranch_scc1 Lgo_8
  s_waitcnt vmcnt(1)
Lgo_8:
  buffer_load_dwordx4 v[84:87], v3, s[8:11], s17 offen nt
  ds_add_rtn_u32 v7, v1, v6 offset:0
  s_add_u32 s17, s17, 8192
  s_waitcnt vmcnt(4) lgkmcnt(0)
  v_readfirstlane_b32 s19, v7
  s_nop 0
  s_cmp_ge_i32 s19, 104
  s_cbranch_scc1 Lgo_9
  s_waitcnt vmcnt(3)
  s_cmp_ge_i32 s19, 96
  s_cbranch_scc1 Lgo_9
  s_waitcnt vmcnt(2)
  s_cmp_ge_i32 s19, 88
  s_cbranch_scc1 Lgo_9
  s_waitcnt vmcnt(1)
Lgo_9:
  buffer_load_dwordx4 v[88:91], v3, s[8:11], s17 offen nt
  ds_add_rtn_u32 v7, v1, v6 offset:0
  s_add_u32 s17, s17, 8192
  s_waitcnt vmcnt(4) lgkmcnt(0)
  v_readfirstlane_b32 s19, v7
  s_nop 0
  s_cmp_ge_i32 s19, 108
  s_cbranch_scc1 Lgo_10
  s_waitcnt vmcnt(3)
  s_cmp_ge_i32 s19, 100
  s_cbranch_scc1 Lgo_10
  s_waitcnt vmcnt(2)
  s_cmp_ge_i32 s19, 92
  s_cbranch_scc1 Lgo_10
  s_waitcnt vmcnt(1)
Lgo_10:
  buffer_load_dwordx4 v[92:95], v3, s[8:11], s17 offen nt
  ds_add_rtn_u32 v7, v1, v6 offset:0
  s_add_u32 s17, s17, 8192
  s_waitcnt vmcnt(4) lgkmcnt(0)
  v_readfirstlane_b32 s19, v7
  s_nop 0
  s_cmp_ge_i32 s19, 118
  s_cbranch_scc1 Lgo_11
  s_waitcnt vmcnt(3)
  s_cmp_ge_i32 s19, 110
  s_cbranch_scc1 Lgo_11
  s_waitcnt vmcnt(2)
  s_cmp_ge_i32 s19, 102
  s_cbranch_scc1 Lgo_11
  s_waitcnt vmcnt(1)
Lgo_11:
  buffer_load_dwordx4 v[96:99], v3, s[8:11], s17 offen nt
  ds_add_rtn_u32 v7, v1, v6 offset:0
  s_add_u32 s17, s17, 8192
  s_waitcnt vmcnt(4) lgkmcnt(0)
  v_readfirstlane_b32 s19, v7
  s_nop 0
  s_cmp_ge_i32 s19, 122
  s_cbranch_scc1 Lgo_12
  s_waitcnt vmcnt(3)
  s_cmp_ge_i32 s19, 114
  s_cbranch_scc1 Lgo_12
  s_waitcnt vmcnt(2)
  s_cmp_ge_i32 s19, 106
  s_cbranch_scc1 Lgo_12
  s_waitcnt vmcnt(1)
Lgo_12:
  buffer_load_dwordx4 v[100:103], v3, s[8:11], s17 offen nt
  ds_add_rtn_u32 v7, v1, v6 offset:0
  s_add_u32 s17, s17, 8192
  s_waitcnt vmcnt(4) lgkmcnt(0)
  v_readfirstlane_b32 s19, v7
  s_nop 0
  s_cmp_ge_i32 s19, 136
  s_cbranch_scc1 Lgo_13
  s_waitcnt vmcnt(3)
  s_cmp_ge_i32 s19, 128
  s_cbranch_scc1 Lgo_13
  s_waitcnt vmcnt(2)
  s_cmp_ge_i32 s19, 120
  s_cbranch_scc1 Lgo_13
  s_waitcnt vmcnt(1)
Lgo_13:
  buffer_load_dwordx4 v[104:107], v3, s[8:11], s17 offen nt
  ds_add_rtn_u32 v7, v1, v6 offset:0
  s_add_u32 s17, s17, 8192
  s_waitcnt vmcnt(4) lgkmcnt(0)
  v_readfirstlane_b32 s19, v7
  s_nop 0
  s_cmp_ge_i32 s19, 140
  s_cbranch_scc1 Lgo_14
  s_waitcnt vmcnt(3)
  s_cmp_ge_i32 s19, 132
  s_cbranch_scc1 Lgo_14
  s_waitcnt vmcnt(2)
  s_cmp_ge_i32 s19, 124
  s_cbranch_scc1 Lgo_14
  s_waitcnt vmcnt(1)
Lgo_14:
  buffer_load_dwordx4 v[108:111], v3, s[8:11], s17 offen nt
  ds_add_rtn_u32 v7, v1, v6 offset:0
  s_add_u32 s17, s17, 8192
  s_waitcnt vmcnt(4) lgkmcnt(0)
  v_readfirstlane_b32 s19, v7
  s_nop 0
  s_cmp_ge_i32 s19, 150
  s_cbranch_scc1 Lgo_15
  s_waitcnt vmcnt(3)
  s_cmp_ge_i32 s19, 142
  s_cbranch_scc1 Lgo_15
  s_waitcnt vmcnt(2)
  s_cmp_ge_i32 s19, 134
  s_cbranch_scc1 Lgo_15
  s_waitcnt vmcnt(1)
Lgo_15:
  buffer_load_dwordx4 v[112:115], v3, s[8:11], s17 offen nt
  ds_add_rtn_u32 v7, v1, v6 offset:0
  s_add_u32 s17, s17, 8192
  s_waitcnt vmcnt(4) lgkmcnt(0)
  v_readfirstlane_b32 s19, v7
  s_nop 0
  s_cmp_ge_i32 s19, 154
  s_cbranch_scc1 Lgo_16
  s_waitcnt vmcnt(3)
  s_cmp_ge_i32 s19, 146
  s_cbranch_scc1 Lgo_16
  s_waitcnt vmcnt(2)
  s_cmp_ge_i32 s19, 138
  s_cbranch_scc1 Lgo_16
  s_waitcnt vmcnt(1)
Lgo_16:
  buffer_load_dwordx4 v[116:119], v3, s[8:11], s17 offen nt
  ds_add_rtn_u32 v7, v1, v6 offset:0
  s_add_u32 s17, s17, 8192
  s_waitcnt vmcnt(4) lgkmcnt(0)
  v_readfirstlane_b32 s19, v7
  s_nop 0
  s_cmp_ge_i32 s19, 168
  s_cbranch_scc1 Lgo_17
  s_waitcnt vmcnt(3)
  s_cmp_ge_i32 s19, 160
  s_cbranch_scc1 Lgo_17
  s_waitcnt vmcnt(2)
  s_cmp_ge_i32 s19, 152
  s_cbranch_scc1 Lgo_17
  s_waitcnt vmcnt(1)
Lgo_17:
  buffer_load_dwordx4 v[120:123], v3, s[8:11], s17 offen nt
  ds_add_rtn_u32 v7, v1, v6 offset:0
  s_add_u32 s17, s17, 8192
  s_waitcnt vmcnt(4) lgkmcnt(0)
  v_readfirstlane_b32 s19, v7
  s_nop 0
  s_cmp_ge_i32 s19, 172
  s_cbranch_scc1 Lgo_18
  s_waitcnt vmcnt(3)
  s_cmp_ge_i32 s19, 164
  s_cbranch_scc1 Lgo_18
  s_waitcnt vmcnt(2)
  s_cmp_ge_i32 s19, 156
  s_cbranch_scc1 Lgo_18
  s_waitcnt vmcnt(1)
Lgo_18:
  buffer_load_dwordx4 v[124:127], v3, s[8:11], s17 offen nt
  ds_add_rtn_u32 v7, v1, v6 offset:0
  s_mul_i32 s17, s6, 81920
  s_add_u32 s17, s17, s33
  s_waitcnt vmcnt(4) lgkmcnt(0)
  v_readfirstlane_b32 s19, v7
  s_nop 0
  s_cmp_ge_i32 s19, 182
  s_cbranch_scc1 Lgo_19
  s_waitcnt vmcnt(3)
  s_cmp_ge_i32 s19, 174
  s_cbranch_scc1 Lgo_19
  s_waitcnt vmcnt(2)
  s_cmp_ge_i32 s19, 166
  s_cbranch_scc1 Lgo_19
  s_waitcnt vmcnt(1)
Lgo_19:
  buffer_load_dwordx4 v[128:131], v3, s[8:11], s17 offen nt
  ds_add_rtn_u32 v7, v1, v6 offset:0
  s_add_u32 s17, s17, 8192
  s_waitcnt vmcnt(4) lgkmcnt(0)
  v_readfirstlane_b32 s19, v7
  s_nop 0
  s_cmp_ge_i32 s19, 186
  s_cbranch_scc1 Lgo_20
  s_waitcnt vmcnt(3)
  s_cmp_ge_i32 s19, 178
  s_cbranch_scc1 Lgo_20
  s_waitcnt vmcnt(2)
  s_cmp_ge_i32 s19, 170
  s_cbranch_scc1 Lgo_20
  s_waitcnt vmcnt(1)
Lgo_20:
  buffer_load_dwordx4 v[132:135], v3, s[8:11], s17 offen nt
  ds_add_rtn_u32 v7, v1, v6 offset:0
  s_add_u32 s17, s17, 8192
  s_waitcnt vmcnt(4) lgkmcnt(0)
  v_readfirstlane_b32 s19, v7
  s_nop 0
  s_cmp_ge_i32 s19, 200
  s_cbranch_scc1 Lgo_21
  s_waitcnt vmcnt(3)
  s_cmp_ge_i32 s19, 192
  s_cbranch_scc1 Lgo_21
  s_waitcnt vmcnt(2)
  s_cmp_ge_i32 s19, 184
  s_cbranch_scc1 Lgo_21
  s_waitcnt vmcnt(1)
Lgo_21:
  buffer_load_dwordx4 v[136:139], v3, s[8:11], s17 offen nt
  ds_add_rtn_u32 v7, v1, v6 offset:0
  s_add_u32 s17, s17, 8192
  s_waitcnt vmcnt(4) lgkmcnt(0)
  v_readfirstlane_b32 s19, v7
  s_nop 0
  s_cmp_ge_i32 s19, 204
  s_cbranch_scc1 Lgo_22
  s_waitcnt vmcnt(3)
  s_cmp_ge_i32 s19, 196
  s_cbranch_scc1 Lgo_22
  s_waitcnt vmcnt(2)
  s_cmp_ge_i32 s19, 188
  s_cbranch_scc1 Lgo_22
  s_waitcnt vmcnt(1)
Lgo_22:
  buffer_load_dwordx4 v[140:143], v3, s[8:11], s17 offen nt
  ds_add_rtn_u32 v7, v1, v6 offset:0
  s_add_u32 s17, s17, 8192
  s_waitcnt vmcnt(4) lgkmcnt(0)
  v_readfirstlane_b32 s19, v7
  s_nop 0
  s_cmp_ge_i32 s19, 214
  s_cbranch_scc1 Lgo_23
  s_waitcnt vmcnt(3)
  s_cmp_ge_i32 s19, 206
  s_cbranch_scc1 Lgo_23
  s_waitcnt vmcnt(2)
  s_cmp_ge_i32 s19, 198
  s_cbranch_scc1 Lgo_23
  s_waitcnt vmcnt(1)
Lgo_23:
  buffer_load_dwordx4 v[144:147], v3, s[8:11], s17 offen nt
  ds_add_rtn_u32 v7, v1, v6 offset:0
  s_add_u32 s17, s17, 8192
  s_waitcnt vmcnt(4) lgkmcnt(0)
  v_readfirstlane_b32 s19, v7
  s_nop 0
  s_cmp_ge_i32 s19, 218
  s_cbranch_scc1 Lgo_24
  s_waitcnt vmcnt(3)
  s_cmp_ge_i32 s19, 210
  s_cbranch_scc1 Lgo_24
  s_waitcnt vmcnt(2)
  s_cmp_ge_i32 s19, 202
  s_cbranch_scc1 Lgo_24
  s_waitcnt vmcnt(1)
Lgo_24:
  buffer_load_dwordx4 v[148:151], v3, s[8:11], s17 offen nt
  ds_add_rtn_u32 v7, v1, v6 offset:0
  s_add_u32 s17, s17, 8192
  s_waitcnt vmcnt(4) lgkmcnt(0)
  v_readfirstlane_b32 s19, v7
  s_nop 0
  s_cmp_ge_i32 s19, 232
  s_cbranch_scc1 Lgo_25
  s_waitcnt vmcnt(3)
  s_cmp_ge_i32 s19, 224
  s_cbranch_scc1 Lgo_25
  s_waitcnt vmcnt(2)
  s_cmp_ge_i32 s19, 216
  s_cbranch_scc1 Lgo_25
  s_waitcnt vmcnt(1)
Lgo_25:
  buffer_load_dwordx4 v[152:155], v3, s[8:11], s17 offen nt
  ds_add_rtn_u32 v7, v1, v6 offset:0
  s_add_u32 s17, s17, 8192
  s_waitcnt vmcnt(4) lgkmcnt(0)
  v_readfirstlane_b32 s19, v7
  s_nop 0
  s_cmp_ge_i32 s19, 236
  s_cbranch_scc1 Lgo_26
  s_waitcnt vmcnt(3)
  s_cmp_ge_i32 s19, 228
  s_cbranch_scc1 Lgo_26
  s_waitcnt vmcnt(2)
  s_cmp_ge_i32 s19, 220
  s_cbranch_scc1 Lgo_26
  s_waitcnt vmcnt(1)
Lgo_26:
  buffer_load_dwordx4 v[156:159], v3, s[8:11], s17 offen nt
  ds_add_rtn_u32 v7, v1, v6 offset:0
  s_add_u32 s17, s17, 8192
  s_waitcnt vmcnt(4) lgkmcnt(0)
  v_readfirstlane_b32 s19, v7
  s_nop 0
  s_cmp_ge_i32 s19, 246
  s_cbranch_scc1 Lgo_27
  s_waitcnt vmcnt(3)
  s_cmp_ge_i32 s19, 238
  s_cbranch_scc1 Lgo_27
  s_waitcnt vmcnt(2)
  s_cmp_ge_i32 s19, 230
  s_cbranch_scc1 Lgo_27
  s_waitcnt vmcnt(1)
Lgo_27:
  buffer_load_dwordx4 v[160:163], v3, s[8:11], s17 offen nt
  ds_add_rtn_u32 v7, v1, v6 offset:0
  s_add_u32 s17, s17, 8192
  s_waitcnt vmcnt(4) lgkmcnt(0)
  v_readfirstlane_b32 s19, v7
  s_nop 0
  s_cmp_ge_i32 s19, 250
  s_cbranch_scc1 Lgo_28
  s_waitcnt vmcnt(3)
  s_cmp_ge_i32 s19, 242
  s_cbranch_scc1 Lgo_28
  s_waitcnt vmcnt(2)
  s_cmp_ge_i32 s19, 234
  s_cbranch_scc1 Lgo_28
  s_waitcnt vmcnt(1)
Lgo_28:
  buffer_load_dwordx4 v[164:167], v3, s[8:11], s17 offen nt
  ds_add_rtn_u32 v7, v1, v6 offset:0
  s_mov_b32 s74, 0
  s_mul_i32 s75, s3, 12288
  s_add_u32 s75, s75, 59392
  s_sub_u32 s17, s16, 8192
L_vq:
  s_waitcnt vmcnt(3) lgkmcnt(0)
  v_readlane_b32 s76, v7, 2
  s_lshl_b32 s19, s74, 10
  s_add_u32 s19, s19, s75
  s_mov_b32 m0, s19
  s_add_u32 s17, s17, 8192
  buffer_load_dwordx4 v2, s[12:15], s17 offen nt lds
  ds_add_rtn_u32 v7, v1, v6 offset:0
  s_add_u32 s74, s74, 1
  s_cmp_lt_u32 s74, 3
  s_cbranch_scc1 L_vq
  s_cmp_lg_u32 s76, 0
  s_cbranch_scc1 L_qk
  s_cmp_lt_u32 s74, 9
  s_cbranch_scc1 L_vq
  v_mov_b32 v12, 0
  s_mov_b32 s34, 0
Lw_29:
  ds_read_b32 v13, v12 offset:8
  s_waitcnt lgkmcnt(0)
  v_readfirstlane_b32 s35, v13
  s_nop 0
  s_cmp_eq_u32 s35, 1
  s_nop 1
  s_cbranch_scc1 Lwe_30
  s_sleep 1
  s_add_u32 s34, s34, 1
  s_cmp_lt_u32 s34, 800000
  s_cbranch_scc1 Lw_29
Lwe_30:
L_qk:
  ds_read_b128 v[8:11], v4 offset:128
  s_waitcnt lgkmcnt(0)
  v_cndmask_b32 v24, 0, v8, s[66:67]
  v_cndmask_b32 v25, 0, v9, s[66:67]
  v_cndmask_b32 v26, 0, v10, s[66:67]
  v_cndmask_b32 v27, 0, v11, s[66:67]
  v_cndmask_b32 v28, 0, v8, s[68:69]
  v_cndmask_b32 v29, 0, v9, s[68:69]
  v_cndmask_b32 v30, 0, v10, s[68:69]
  v_cndmask_b32 v31, 0, v11, s[68:69]
  v_cndmask_b32 v32, 0, v8, s[70:71]
  v_cndmask_b32 v33, 0, v9, s[70:71]
  v_cndmask_b32 v34, 0, v10, s[70:71]
  v_cndmask_b32 v35, 0, v11, s[70:71]
  v_cndmask_b32 v36, 0, v8, s[72:73]
  v_cndmask_b32 v37, 0, v9, s[72:73]
  v_cndmask_b32 v38, 0, v10, s[72:73]
  v_cndmask_b32 v39, 0, v11, s[72:73]
  s_mul_i32 s18, s5, 10240
  s_add_u32 s72, s18, 360448
  s_add_u32 s72, s62, s72
  s_addc_u32 s73, s63, 0
  v_mfma_f32_16x16x32_bf16 v[16:19], v[40:43], v[24:27], 0
  v_mfma_f32_16x16x32_bf16 v[16:19], v[44:47], v[28:31], v[16:19]
  v_mfma_f32_16x16x32_bf16 v[16:19], v[48:51], v[32:35], v[16:19]
  v_mfma_f32_16x16x32_bf16 v[16:19], v[52:55], v[36:39], v[16:19]
  v_mfma_f32_16x16x32_bf16 v[20:23], v[56:59], v[24:27], 0
  v_mfma_f32_16x16x32_bf16 v[20:23], v[60:63], v[28:31], v[20:23]
  v_mfma_f32_16x16x32_bf16 v[20:23], v[64:67], v[32:35], v[20:23]
  v_mfma_f32_16x16x32_bf16 v[20:23], v[68:71], v[36:39], v[20:23]
  s_nop 3
  v_cndmask_b32 v8, v16, v17, s[20:21]
  v_cndmask_b32 v8, v8, v18, s[22:23]
  v_cndmask_b32 v8, v8, v19, s[24:25]
  v_mfma_f32_16x16x32_bf16 v[16:19], v[72:75], v[24:27], 0
  v_mfma_f32_16x16x32_bf16 v[16:19], v[76:79], v[28:31], v[16:19]
  v_mfma_f32_16x16x32_bf16 v[16:19], v[80:83], v[32:35], v[16:19]
  v_mfma_f32_16x16x32_bf16 v[16:19], v[84:87], v[36:39], v[16:19]
  v_cndmask_b32 v9, v20, v21, s[20:21]
  v_cndmask_b32 v9, v9, v22, s[22:23]
  v_cndmask_b32 v9, v9, v23, s[24:25]
  s_waitcnt vmcnt(3)
  s_lshl_b32 s19, s74, 10
  s_add_u32 s19, s19, s75
  s_mov_b32 m0, s19
  s_add_u32 s17, s17, 8192
  buffer_load_dwordx4 v2, s[12:15], s17 offen nt lds
  ds_add_rtn_u32 v7, v1, v6 offset:0
  s_add_u32 s74, s74, 1
  v_mfma_f32_16x16x32_bf16 v[20:23], v[88:91], v[24:27], 0
  v_mfma_f32_16x16x32_bf16 v[20:23], v[92:95], v[28:31], v[20:23]
  v_mfma_f32_16x16x32_bf16 v[20:23], v[96:99], v[32:35], v[20:23]
  v_mfma_f32_16x16x32_bf16 v[20:23], v[100:103], v[36:39], v[20:23]
  v_cndmask_b32 v10, v16, v17, s[20:21]
  v_cndmask_b32 v10, v10, v18, s[22:23]
  v_cndmask_b32 v10, v10, v19, s[24:25]
  v_mfma_f32_16x16x32_bf16 v[16:19], v[104:107], v[24:27], 0
  v_mfma_f32_16x16x32_bf16 v[16:19], v[108:111], v[28:31], v[16:19]
  v_mfma_f32_16x16x32_bf16 v[16:19], v[112:115], v[32:35], v[16:19]
  v_mfma_f32_16x16x32_bf16 v[16:19], v[116:119], v[36:39], v[16:19]
  s_nop 0
  v_cndmask_b32 v11, v20, v21, s[20:21]
  v_cndmask_b32 v11, v11, v22, s[22:23]
  v_cndmask_b32 v11, v11, v23, s[24:25]
  v_cndmask_b32 v12, v8, v9, s[26:27]
  v_cndmask_b32 v13, v9, v8, s[26:27]
  v_cndmask_b32 v8, v10, v11, s[26:27]
  v_cndmask_b32 v9, v11, v10, s[26:27]
  v_add_f32_dpp v12, v13, v12 quad_perm:[1,0,3,2] row_mask:0xf bank_mask:0xf
  s_nop 0
  v_add_f32_dpp v8, v9, v8 quad_perm:[1,0,3,2] row_mask:0xf bank_mask:0xf
  v_cndmask_b32 v10, v12, v8, s[28:29]
  v_cndmask_b32 v11, v8, v12, s[28:29]
  s_nop 1
  v_add_f32_dpp v4, v11, v10 quad_perm:[2,3,0,1] row_mask:0xf bank_mask:0xf
  v_mfma_f32_16x16x32_bf16 v[20:23], v[120:123], v[24:27], 0
  v_mfma_f32_16x16x32_bf16 v[20:23], v[124:127], v[28:31], v[20:23]
  v_mfma_f32_16x16x32_bf16 v[20:23], v[128:131], v[32:35], v[20:23]
  v_mfma_f32_16x16x32_bf16 v[20:23], v[132:135], v[36:39], v[20:23]
  v_cndmask_b32 v8, v16, v17, s[20:21]
  v_cndmask_b32 v8, v8, v18, s[22:23]
  v_cndmask_b32 v8, v8, v19, s[24:25]
  s_waitcnt vmcnt(3)
  s_lshl_b32 s19, s74, 10
  s_add_u32 s19, s19, s75
  s_mov_b32 m0, s19
  s_add_u32 s17, s17, 8192
  buffer_load_dwordx4 v2, s[12:15], s17 offen nt lds
  ds_add_rtn_u32 v7, v1, v6 offset:0
  s_add_u32 s74, s74, 1
  v_mfma_f32_16x16x32_bf16 v[16:19], v[136:139], v[24:27], 0
  v_mfma_f32_16x16x32_bf16 v[16:19], v[140:143], v[28:31], v[16:19]
  v_mfma_f32_16x16x32_bf16 v[16:19], v[144:147], v[32:35], v[16:19]
  v_mfma_f32_16x16x32_bf16 v[16:19], v[148:151], v[36:39], v[16:19]
  v_cndmask_b32 v9, v20, v21, s[20:21]
  v_cndmask_b32 v9, v9, v22, s[22:23]
  v_cndmask_b32 v9, v9, v23, s[24:25]
  s_waitcnt vmcnt(5)
  v_mfma_f32_16x16x32_bf16 v[20:23], v[152:155], v[24:27], 0
  v_mfma_f32_16x16x32_bf16 v[20:23], v[156:159], v[28:31], v[20:23]
  v_mfma_f32_16x16x32_bf16 v[20:23], v[160:163], v[32:35], v[20:23]
  v_mfma_f32_16x16x32_bf16 v[20:23], v[164:167], v[36:39], v[20:23]
  v_cndmask_b32 v10, v16, v17, s[20:21]
  v_cndmask_b32 v10, v10, v18, s[22:23]
  v_cndmask_b32 v10, v10, v19, s[24:25]
  s_nop 4
  v_cndmask_b32 v11, v20, v21, s[20:21]
  v_cndmask_b32 v11, v11, v22, s[22:23]
  v_cndmask_b32 v11, v11, v23, s[24:25]
  v_cndmask_b32 v12, v8, v9, s[26:27]
  v_cndmask_b32 v13, v9, v8, s[26:27]
  v_cndmask_b32 v8, v10, v11, s[26:27]
  v_cndmask_b32 v9, v11, v10, s[26:27]
  v_add_f32_dpp v12, v13, v12 quad_perm:[1,0,3,2] row_mask:0xf bank_mask:0xf
  s_nop 0
  v_add_f32_dpp v8, v9, v8 quad_perm:[1,0,3,2] row_mask:0xf bank_mask:0xf
  v_cndmask_b32 v10, v12, v8, s[28:29]
  v_cndmask_b32 v11, v8, v12, s[28:29]
  s_nop 1
  v_add_f32_dpp v5, v11, v10 quad_perm:[2,3,0,1] row_mask:0xf bank_mask:0xf
  v_cvt_pk_bf16_f32 v8, v4, v5
  v_lshlrev_b32 v4, 16, v8
  v_and_b32 v5, 0xffff0000, v8
  v_mul_f32 v4, 1035273459, v4
  v_mul_f32 v5, 1035273459, v5
  v_cvt_pk_bf16_f32 v8, v4, v5
  v_lshlrev_b32 v4, 16, v8
  v_and_b32 v5, 0xffff0000, v8
  v_max_f32 v8, v4, v5
  s_nop 1
  v_max_f32_dpp v8, v8, v8 quad_perm:[1,0,3,2] row_mask:0xf bank_mask:0xf
  s_nop 1
  v_max_f32_dpp v8, v8, v8 quad_perm:[2,3,0,1] row_mask:0xf bank_mask:0xf
  s_nop 1
  v_max_f32_dpp v8, v8, v8 row_half_mirror row_mask:0xf bank_mask:0xf
  s_nop 1
  v_max_f32_dpp v8, v8, v8 row_mirror row_mask:0xf bank_mask:0xf
  s_nop 1
  v_max_f32_dpp v8, v8, v8 row_bcast:15 row_mask:0xa bank_mask:0xf
  s_nop 1
  v_max_f32_dpp v8, v8, v8 row_bcast:31 row_mask:0xc bank_mask:0xf
  s_nop 0
  v_readlane_b32 s18, v8, 63
  s_waitcnt vmcnt(3)
  s_lshl_b32 s19, s74, 10
  s_add_u32 s19, s19, s75
  s_mov_b32 m0, s19
  s_add_u32 s17, s17, 8192
  buffer_load_dwordx4 v2, s[12:15], s17 offen nt lds
  ds_add_rtn_u32 v7, v1, v6 offset:0
  s_add_u32 s74, s74, 1
  v_subrev_f32 v10, s18, v4
  v_subrev_f32 v11, s18, v5
  v_mul_f32 v10, 1069066811, v10
  v_mul_f32 v11, 1069066811, v11
  v_exp_f32 v10, v10
  v_exp_f32 v11, v11
  s_nop 0
  v_add_f32 v9, v10, v11
  s_nop 1
  v_add_f32_dpp v9, v9, v9 quad_perm:[1,0,3,2] row_mask:0xf bank_mask:0xf
  s_nop 1
  v_add_f32_dpp v9, v9, v9 quad_perm:[2,3,0,1] row_mask:0xf bank_mask:0xf
  s_nop 1
  v_add_f32_dpp v9, v9, v9 row_half_mirror row_mask:0xf bank_mask:0xf
  s_nop 1
  v_add_f32_dpp v9, v9, v9 row_mirror row_mask:0xf bank_mask:0xf
  s_nop 1
  v_add_f32_dpp v9, v9, v9 row_bcast:15 row_mask:0xa bank_mask:0xf
  s_nop 1
  v_add_f32_dpp v9, v9, v9 row_bcast:31 row_mask:0xc bank_mask:0xf
  v_and_b32 v10, 3, v0
  v_lshlrev_b32 v10, 9, v10
  v_bfe_u32 v11, v0, 2, 2
  v_lshl_add_u32 v10, v11, 7, v10
  v_lshrrev_b32 v11, 4, v0
  v_lshl_add_u32 v10, v11, 2, v10
  s_lshl_b32 s19, s3, 4
  s_add_u32 s19, s19, 56576
  v_add_u32 v10, s19, v10
  s_mov_b32 exec_lo, 4006407884
  s_mov_b32 exec_hi, 4006407884
  ds_write_b32 v10, v5
  s_mov_b64 exec, -1
  v_mov_b32 v10, 0
  v_mov_b32 v11, 1
  s_mov_b32 exec_lo, 0
  s_mov_b32 exec_hi, 0x80000000
  ds_write_b64 v15, v[8:9] offset:384
  ds_add_rtn_u32 v12, v10, v11 offset:20
  s_waitcnt lgkmcnt(0)
  v_readfirstlane_b32 s18, v12
  s_mov_b64 exec, -1
  s_cmp_lg_u32 s18, 7
  s_nop 1
  s_cbranch_scc1 Lnp_31
  v_and_b32 v12, 7, v0
  v_lshlrev_b32 v12, 3, v12
  ds_read_b64 v[8:9], v12 offset:384
  ds_read_b32 v21, v10 offset:24
  s_waitcnt lgkmcnt(0)
  v_mov_b32 v20, v8
  s_nop 1
  v_max_f32_dpp v20, v20, v20 quad_perm:[1,0,3,2] row_mask:0xf bank_mask:0xf
  s_nop 1
  v_max_f32_dpp v20, v20, v20 quad_perm:[2,3,0,1] row_mask:0xf bank_mask:0xf
  s_nop 1
  v_max_f32_dpp v20, v20, v20 row_half_mirror row_mask:0xf bank_mask:0xf
  v_sub_f32 v8, v8, v20
  v_mul_f32 v8, 1069066811, v8
  v_exp_f32 v8, v8
  s_nop 0
  v_mul_f32 v22, v9, v8
  s_nop 1
  v_add_f32_dpp v22, v22, v22 quad_perm:[1,0,3,2] row_mask:0xf bank_mask:0xf
  s_nop 1
  v_add_f32_dpp v22, v22, v22 quad_perm:[2,3,0,1] row_mask:0xf bank_mask:0xf
  s_nop 1
  v_add_f32_dpp v22, v22, v22 row_half_mirror row_mask:0xf bank_mask:0xf
  v_mov_b32 v23, v21
  s_mov_b64 exec, 0xff
  global_store_dwordx4 v2, v[20:23], s[30:31] sc1
  s_mov_b64 exec, -1
Lnp_31:
  v_and_b32 v12, 1, v0
  v_lshlrev_b32 v12, 4, v12
  v_mov_b32 v13, 0xffff
  v_lshlrev_b32 v13, v12, v13
  v_bfe_u32 v12, v0, 1, 2
  v_cmp_eq_u32 vcc, 0, v12
  s_nop 1
  v_cndmask_b32 v24, 0, v13, vcc
  v_cmp_eq_u32 vcc, 1, v12
  s_nop 1
  v_cndmask_b32 v25, 0, v13, vcc
  v_cmp_eq_u32 vcc, 2, v12
  s_nop 1
  v_cndmask_b32 v26, 0, v13, vcc
  v_cmp_eq_u32 vcc, 3, v12
  s_nop 1
  v_cndmask_b32 v27, 0, v13, vcc
  s_cmp_eq_u32 s74, 7
  s_cbranch_scc1 L_v7
  s_cmp_eq_u32 s74, 8
  s_cbranch_scc1 L_v8
  s_cmp_eq_u32 s74, 9
  s_cbranch_scc1 L_v9
  s_cmp_eq_u32 s74, 10
  s_cbranch_scc1 L_v10
  s_cmp_eq_u32 s74, 11
  s_cbranch_scc1 L_v11
  s_cmp_eq_u32 s74, 12
  s_cbranch_scc1 L_v12
L_v6:
  s_add_u32 s17, s17, 8192
  s_waitcnt vmcnt(4) lgkmcnt(0)
  v_readfirstlane_b32 s19, v7
  s_nop 0
  s_cmp_ge_i32 s19, 310
  s_cbranch_scc1 Lgo_32
  s_waitcnt vmcnt(3)
  s_cmp_ge_i32 s19, 302
  s_cbranch_scc1 Lgo_32
  s_waitcnt vmcnt(2)
  s_cmp_ge_i32 s19, 294
  s_cbranch_scc1 Lgo_32
  s_waitcnt vmcnt(1)
Lgo_32:
  buffer_load_dwordx4 v[64:67], v2, s[12:15], s17 offen nt
  ds_add_rtn_u32 v7, v1, v6 offset:0
L_v7:
  s_add_u32 s17, s17, 8192
  s_waitcnt vmcnt(4) lgkmcnt(0)
  v_readfirstlane_b32 s19, v7
  s_nop 0
  s_cmp_ge_i32 s19, 314
  s_cbranch_scc1 Lgo_33
  s_waitcnt vmcnt(3)
  s_cmp_ge_i32 s19, 306
  s_cbranch_scc1 Lgo_33
  s_waitcnt vmcnt(2)
  s_cmp_ge_i32 s19, 298
  s_cbranch_scc1 Lgo_33
  s_waitcnt vmcnt(1)
Lgo_33:
  buffer_load_dwordx4 v[68:71], v2, s[12:15], s17 offen nt
  ds_add_rtn_u32 v7, v1, v6 offset:0
L_v8:
  s_add_u32 s17, s17, 8192
  s_waitcnt vmcnt(4) lgkmcnt(0)
  v_readfirstlane_b32 s19, v7
  s_nop 0
  s_cmp_ge_i32 s19, 328
  s_cbranch_scc1 Lgo_34
  s_waitcnt vmcnt(3)
  s_cmp_ge_i32 s19, 320
  s_cbranch_scc1 Lgo_34
  s_waitcnt vmcnt(2)
  s_cmp_ge_i32 s19, 312
  s_cbranch_scc1 Lgo_34
  s_waitcnt vmcnt(1)
Lgo_34:
  buffer_load_dwordx4 v[72:75], v2, s[12:15], s17 offen nt
  ds_add_rtn_u32 v7, v1, v6 offset:0
L_v9:
  s_add_u32 s17, s17, 8192
  s_waitcnt vmcnt(4) lgkmcnt(0)
  v_readfirstlane_b32 s19, v7
  s_nop 0
  s_cmp_ge_i32 s19, 332
  s_cbranch_scc1 Lgo_35
  s_waitcnt vmcnt(3)
  s_cmp_ge_i32 s19, 324
  s_cbranch_scc1 Lgo_35
  s_waitcnt vmcnt(2)
  s_cmp_ge_i32 s19, 316
  s_cbranch_scc1 Lgo_35
  s_waitcnt vmcnt(1)
Lgo_35:
  buffer_load_dwordx4 v[76:79], v2, s[12:15], s17 offen nt
  ds_add_rtn_u32 v7, v1, v6 offset:0
L_v10:
  s_add_u32 s17, s17, 8192
  s_waitcnt vmcnt(4) lgkmcnt(0)
  v_readfirstlane_b32 s19, v7
  s_nop 0
  s_cmp_ge_i32 s19, 342
  s_cbranch_scc1 Lgo_36
  s_waitcnt vmcnt(3)
  s_cmp_ge_i32 s19, 334
  s_cbranch_scc1 Lgo_36
  s_waitcnt vmcnt(2)
  s_cmp_ge_i32 s19, 326
  s_cbranch_scc1 Lgo_36
  s_waitcnt vmcnt(1)
Lgo_36:
  buffer_load_dwordx4 v[80:83], v2, s[12:15], s17 offen nt
  ds_add_rtn_u32 v7, v1, v6 offset:0
L_v11:
  s_add_u32 s17, s17, 8192
  s_waitcnt vmcnt(4) lgkmcnt(0)
  v_readfirstlane_b32 s19, v7
  s_nop 0
  s_cmp_ge_i32 s19, 346
  s_cbranch_scc1 Lgo_37
  s_waitcnt vmcnt(3)
  s_cmp_ge_i32 s19, 338
  s_cbranch_scc1 Lgo_37
  s_waitcnt vmcnt(2)
  s_cmp_ge_i32 s19, 330
  s_cbranch_scc1 Lgo_37
  s_waitcnt vmcnt(1)
Lgo_37:
  buffer_load_dwordx4 v[84:87], v2, s[12:15], s17 offen nt
  ds_add_rtn_u32 v7, v1, v6 offset:0
L_v12:
  s_add_u32 s17, s17, 8192
  s_waitcnt vmcnt(4) lgkmcnt(0)
  v_readfirstlane_b32 s19, v7
  s_nop 0
  s_cmp_ge_i32 s19, 360
  s_cbranch_scc1 Lgo_38
  s_waitcnt vmcnt(3)
  s_cmp_ge_i32 s19, 352
  s_cbranch_scc1 Lgo_38
  s_waitcnt vmcnt(2)
  s_cmp_ge_i32 s19, 344
  s_cbranch_scc1 Lgo_38
  s_waitcnt vmcnt(1)
Lgo_38:
  buffer_load_dwordx4 v[88:91], v2, s[12:15], s17 offen nt
  ds_add_rtn_u32 v7, v1, v6 offset:0
  v_add_u32 v12, s75, v2
  ds_read_b128 v[40:43], v12 offset:0
  ds_read_b128 v[44:47], v12 offset:1024
  ds_read_b128 v[48:51], v12 offset:2048
  ds_read_b128 v[52:55], v12 offset:3072
Lcp_39:
  s_add_u32 s17, s17, 8192
  s_waitcnt vmcnt(4) lgkmcnt(0)
  v_readfirstlane_b32 s19, v7
  s_nop 0
  s_cmp_ge_i32 s19, 364
  s_cbranch_scc1 Lgo_40
  s_waitcnt vmcnt(3)
  s_cmp_ge_i32 s19, 356
  s_cbranch_scc1 Lgo_40
  s_waitcnt vmcnt(2)
  s_cmp_ge_i32 s19, 348
  s_cbranch_scc1 Lgo_40
  s_waitcnt vmcnt(1)
Lgo_40:
  buffer_load_dwordx4 v[92:95], v2, s[12:15], s17 offen nt
  ds_add_rtn_u32 v7, v1, v6 offset:0
  ds_read_b128 v[56:59], v12 offset:4096
  ds_read_b128 v[60:63], v12 offset:5120
  s_cmp_le_u32 s74, 6
  s_cbranch_scc1 Lcp_41
  ds_read_b128 v[64:67], v12 offset:6144
  s_cmp_le_u32 s74, 7
  s_cbranch_scc1 Lcp_41
  ds_read_b128 v[68:71], v12 offset:7168
Lcp_41:
  s_add_u32 s17, s17, 8192
  s_waitcnt vmcnt(4) lgkmcnt(0)
  v_readfirstlane_b32 s19, v7
  s_nop 0
  s_cmp_ge_i32 s19, 374
  s_cbranch_scc1 Lgo_42
  s_waitcnt vmcnt(3)
  s_cmp_ge_i32 s19, 366
  s_cbranch_scc1 Lgo_42
  s_waitcnt vmcnt(2)
  s_cmp_ge_i32 s19, 358
  s_cbranch_scc1 Lgo_42
  s_waitcnt vmcnt(1)
Lgo_42:
  buffer_load_dwordx4 v[96:99], v2, s[12:15], s17 offen nt
  ds_add_rtn_u32 v7, v1, v6 offset:0
  s_add_u32 s17, s17, 8192
  s_waitcnt vmcnt(4) lgkmcnt(0)
  v_readfirstlane_b32 s19, v7
  s_nop 0
  s_cmp_ge_i32 s19, 378
  s_cbranch_scc1 Lgo_43
  s_waitcnt vmcnt(3)
  s_cmp_ge_i32 s19, 370
  s_cbranch_scc1 Lgo_43
  s_waitcnt vmcnt(2)
  s_cmp_ge_i32 s19, 362
  s_cbranch_scc1 Lgo_43
  s_waitcnt vmcnt(1)
Lgo_43:
  buffer_load_dwordx4 v[100:103], v2, s[12:15], s17 offen nt
  ds_add_rtn_u32 v7, v1, v6 offset:0
  s_add_u32 s17, s17, 8192
  s_waitcnt vmcnt(4) lgkmcnt(0)
  v_readfirstlane_b32 s19, v7
  s_nop 0
  s_cmp_ge_i32 s19, 392
  s_cbranch_scc1 Lgo_44
  s_waitcnt vmcnt(3)
  s_cmp_ge_i32 s19, 384
  s_cbranch_scc1 Lgo_44
  s_waitcnt vmcnt(2)
  s_cmp_ge_i32 s19, 376
  s_cbranch_scc1 Lgo_44
  s_waitcnt vmcnt(1)
Lgo_44:
  buffer_load_dwordx4 v[104:107], v2, s[12:15], s17 offen nt
  ds_add_rtn_u32 v7, v1, v6 offset:0
  s_cmp_le_u32 s74, 8
  s_cbranch_scc1 Lcp_45
  ds_read_b128 v[72:75], v12 offset:8192
  s_cmp_le_u32 s74, 9
  s_cbranch_scc1 Lcp_45
  ds_read_b128 v[76:79], v12 offset:9216
  s_cmp_le_u32 s74, 10
  s_cbranch_scc1 Lcp_45
  ds_read_b128 v[80:83], v12 offset:10240
  s_cmp_le_u32 s74, 11
  s_cbranch_scc1 Lcp_45
  ds_read_b128 v[84:87], v12 offset:11264
Lcp_45:
  s_add_u32 s17, s17, 8192
  s_waitcnt vmcnt(4) lgkmcnt(0)
  v_readfirstlane_b32 s19, v7
  s_nop 0
  s_cmp_ge_i32 s19, 396
  s_cbranch_scc1 Lgo_46
  s_waitcnt vmcnt(3)
  s_cmp_ge_i32 s19, 388
  s_cbranch_scc1 Lgo_46
  s_waitcnt vmcnt(2)
  s_cmp_ge_i32 s19, 380
  s_cbranch_scc1 Lgo_46
  s_waitcnt vmcnt(1)
Lgo_46:
  buffer_load_dwordx4 v[108:111], v2, s[12:15], s17 offen nt
  ds_add_rtn_u32 v7, v1, v6 offset:0
  s_mov_b32 s74, s17
  s_mul_i32 s17, s6, 81920
  s_add_u32 s17, s17, s33
  s_sub_u32 s17, s17, 8192
  s_mov_b32 s77, 0
  s_waitcnt lgkmcnt(0)
  v_readlane_b32 s35, v7, 8
  s_nop 0
  s_and_b32 s18, s35, 0xff
  s_cmp_le_u32 s18, 0
  s_cbranch_scc1 L_olim
L_o0:
  s_add_u32 s17, s17, 8192
  s_waitcnt vmcnt(4) lgkmcnt(0)
  v_readfirstlane_b32 s19, v7
  s_nop 0
  s_cmp_ge_i32 s19, 400
  s_cbranch_scc1 Lgo_47
  s_waitcnt vmcnt(3)
  s_cmp_ge_i32 s19, 392
  s_cbranch_scc1 Lgo_47
  s_waitcnt vmcnt(2)
  s_cmp_ge_i32 s19, 384
  s_cbranch_scc1 Lgo_47
  s_waitcnt vmcnt(1)
Lgo_47:
  buffer_load_dwordx4 v[128:131], v2, s[12:15], s17 offen nt
  ds_add_rtn_u32 v7, v1, v6 offset:0
  s_mov_b32 s77, 1
  s_waitcnt lgkmcnt(0)
  v_readlane_b32 s35, v7, 8
  s_nop 0
  s_and_b32 s18, s35, 0xff
  s_cmp_le_u32 s18, 1
  s_cbranch_scc1 L_olim
L_o1:
  s_add_u32 s17, s17, 8192
  s_waitcnt vmcnt(4) lgkmcnt(0)
  v_readfirstlane_b32 s19, v7
  s_nop 0
  s_cmp_ge_i32 s19, 404
  s_cbranch_scc1 Lgo_48
  s_waitcnt vmcnt(3)
  s_cmp_ge_i32 s19, 396
  s_cbranch_scc1 Lgo_48
  s_waitcnt vmcnt(2)
  s_cmp_ge_i32 s19, 388
  s_cbranch_scc1 Lgo_48
  s_waitcnt vmcnt(1)
Lgo_48:
  buffer_load_dwordx4 v[132:135], v2, s[12:15], s17 offen nt
  ds_add_rtn_u32 v7, v1, v6 offset:0
  s_mov_b32 s77, 2
  s_waitcnt lgkmcnt(0)
  v_readlane_b32 s35, v7, 8
  s_nop 0
  s_and_b32 s18, s35, 0xff
  s_cmp_le_u32 s18, 2
  s_cbranch_scc1 L_olim
L_o2:
  s_add_u32 s17, s17, 8192
  s_waitcnt vmcnt(4) lgkmcnt(0)
  v_readfirstlane_b32 s19, v7
  s_nop 0
  s_cmp_ge_i32 s19, 418
  s_cbranch_scc1 Lgo_49
  s_waitcnt vmcnt(3)
  s_cmp_ge_i32 s19, 410
  s_cbranch_scc1 Lgo_49
  s_waitcnt vmcnt(2)
  s_cmp_ge_i32 s19, 402
  s_cbranch_scc1 Lgo_49
  s_waitcnt vmcnt(1)
Lgo_49:
  buffer_load_dwordx4 v[136:139], v2, s[12:15], s17 offen nt
  ds_add_rtn_u32 v7, v1, v6 offset:0
  s_mov_b32 s77, 3
  s_waitcnt lgkmcnt(0)
  v_readlane_b32 s35, v7, 8
  s_nop 0
  s_and_b32 s18, s35, 0xff
  s_cmp_le_u32 s18, 3
  s_cbranch_scc1 L_olim
L_o3:
  s_add_u32 s17, s17, 8192
  s_waitcnt vmcnt(4) lgkmcnt(0)
  v_readfirstlane_b32 s19, v7
  s_nop 0
  s_cmp_ge_i32 s19, 422
  s_cbranch_scc1 Lgo_50
  s_waitcnt vmcnt(3)
  s_cmp_ge_i32 s19, 414
  s_cbranch_scc1 Lgo_50
  s_waitcnt vmcnt(2)
  s_cmp_ge_i32 s19, 406
  s_cbranch_scc1 Lgo_50
  s_waitcnt vmcnt(1)
Lgo_50:
  buffer_load_dwordx4 v[140:143], v2, s[12:15], s17 offen nt
  ds_add_rtn_u32 v7, v1, v6 offset:0
  s_mov_b32 s77, 4
  s_waitcnt lgkmcnt(0)
  v_readlane_b32 s35, v7, 8
  s_nop 0
  s_and_b32 s18, s35, 0xff
  s_cmp_le_u32 s18, 4
  s_cbranch_scc1 L_olim
L_o4:
  s_add_u32 s17, s17, 8192
  s_waitcnt vmcnt(4) lgkmcnt(0)
  v_readfirstlane_b32 s19, v7
  s_nop 0
  s_cmp_ge_i32 s19, 432
  s_cbranch_scc1 Lgo_51
  s_waitcnt vmcnt(3)
  s_cmp_ge_i32 s19, 424
  s_cbranch_scc1 Lgo_51
  s_waitcnt vmcnt(2)
  s_cmp_ge_i32 s19, 416
  s_cbranch_scc1 Lgo_51
  s_waitcnt vmcnt(1)
Lgo_51:
  buffer_load_dwordx4 v[144:147], v2, s[12:15], s17 offen nt
  ds_add_rtn_u32 v7, v1, v6 offset:0
  s_mov_b32 s77, 5
  s_waitcnt lgkmcnt(0)
  v_readlane_b32 s35, v7, 8
  s_nop 0
  s_and_b32 s18, s35, 0xff
  s_cmp_le_u32 s18, 5
  s_cbranch_scc1 L_olim
L_o5:
  s_add_u32 s17, s17, 8192
  s_waitcnt vmcnt(4) lgkmcnt(0)
  v_readfirstlane_b32 s19, v7
  s_nop 0
  s_cmp_ge_i32 s19, 436
  s_cbranch_scc1 Lgo_52
  s_waitcnt vmcnt(3)
  s_cmp_ge_i32 s19, 428
  s_cbranch_scc1 Lgo_52
  s_waitcnt vmcnt(2)
  s_cmp_ge_i32 s19, 420
  s_cbranch_scc1 Lgo_52
  s_waitcnt vmcnt(1)
Lgo_52:
  buffer_load_dwordx4 v[148:151], v2, s[12:15], s17 offen nt
  ds_add_rtn_u32 v7, v1, v6 offset:0
  s_mov_b32 s77, 6
  s_waitcnt lgkmcnt(0)
  v_readlane_b32 s35, v7, 8
  s_nop 0
  s_and_b32 s18, s35, 0xff
  s_cmp_le_u32 s18, 6
  s_cbranch_scc1 L_olim
L_o6:
  s_add_u32 s17, s17, 8192
  s_waitcnt vmcnt(4) lgkmcnt(0)
  v_readfirstlane_b32 s19, v7
  s_nop 0
  s_cmp_ge_i32 s19, 450
  s_cbranch_scc1 Lgo_53
  s_waitcnt vmcnt(3)
  s_cmp_ge_i32 s19, 442
  s_cbranch_scc1 Lgo_53
  s_waitcnt vmcnt(2)
  s_cmp_ge_i32 s19, 434
  s_cbranch_scc1 Lgo_53
  s_waitcnt vmcnt(1)
Lgo_53:
  buffer_load_dwordx4 v[152:155], v2, s[12:15], s17 offen nt
  ds_add_rtn_u32 v7, v1, v6 offset:0
  s_mov_b32 s77, 7
  s_waitcnt lgkmcnt(0)
  v_readlane_b32 s35, v7, 8
  s_nop 0
  s_and_b32 s18, s35, 0xff
  s_cmp_le_u32 s18, 7
  s_cbranch_scc1 L_olim
L_o7:
  s_add_u32 s17, s17, 8192
  s_waitcnt vmcnt(4) lgkmcnt(0)
  v_readfirstlane_b32 s19, v7
  s_nop 0
  s_cmp_ge_i32 s19, 454
  s_cbranch_scc1 Lgo_54
  s_waitcnt vmcnt(3)
  s_cmp_ge_i32 s19, 446
  s_cbranch_scc1 Lgo_54
  s_waitcnt vmcnt(2)
  s_cmp_ge_i32 s19, 438
  s_cbranch_scc1 Lgo_54
  s_waitcnt vmcnt(1)
Lgo_54:
  buffer_load_dwordx4 v[156:159], v2, s[12:15], s17 offen nt
  ds_add_rtn_u32 v7, v1, v6 offset:0
  s_mov_b32 s77, 8
  s_waitcnt lgkmcnt(0)
  v_readlane_b32 s35, v7, 8
  s_nop 0
  s_and_b32 s18, s35, 0xff
  s_cmp_le_u32 s18, 8
  s_cbranch_scc1 L_olim
L_o8:
  s_add_u32 s17, s17, 8192
  s_waitcnt vmcnt(4) lgkmcnt(0)
  v_readfirstlane_b32 s19, v7
  s_nop 0
  s_cmp_ge_i32 s19, 464
  s_cbranch_scc1 Lgo_55
  s_waitcnt vmcnt(3)
  s_cmp_ge_i32 s19, 456
  s_cbranch_scc1 Lgo_55
  s_waitcnt vmcnt(2)
  s_cmp_ge_i32 s19, 448
  s_cbranch_scc1 Lgo_55
  s_waitcnt vmcnt(1)
Lgo_55:
  buffer_load_dwordx4 v[160:163], v2, s[12:15], s17 offen nt
  ds_add_rtn_u32 v7, v1, v6 offset:0
  s_mov_b32 s77, 9
  s_waitcnt lgkmcnt(0)
  v_readlane_b32 s35, v7, 8
  s_nop 0
  s_and_b32 s18, s35, 0xff
  s_cmp_le_u32 s18, 9
  s_cbranch_scc1 L_olim
L_o9:
  s_add_u32 s17, s17, 8192
  s_waitcnt vmcnt(4) lgkmcnt(0)
  v_readfirstlane_b32 s19, v7
  s_nop 0
  s_cmp_ge_i32 s19, 468
  s_cbranch_scc1 Lgo_56
  s_waitcnt vmcnt(3)
  s_cmp_ge_i32 s19, 460
  s_cbranch_scc1 Lgo_56
  s_waitcnt vmcnt(2)
  s_cmp_ge_i32 s19, 452
  s_cbranch_scc1 Lgo_56
  s_waitcnt vmcnt(1)
Lgo_56:
  buffer_load_dwordx4 v[164:167], v2, s[12:15], s17 offen nt
  ds_add_rtn_u32 v7, v1, v6 offset:0
  s_mov_b32 s77, 10
  s_waitcnt lgkmcnt(0)
  v_readlane_b32 s35, v7, 8
L_olim:
  s_mov_b32 s34, 0
L_olp:
  s_and_b32 s18, s35, 0xff
  s_cmp_gt_u32 s18, s77
  s_nop 0
  s_cbranch_scc1 L_oback
  s_bitcmp1_b32 s35, 16
  s_cbranch_scc1 L_odone
  s_sleep 1
  ds_read_b32 v7, v1
  s_waitcnt lgkmcnt(0)
  v_readlane_b32 s35, v7, 8
  s_add_u32 s34, s34, 1
  s_cmp_lt_u32 s34, 800000
  s_nop 1
  s_cbranch_scc1 L_olp
  s_branch L_odone
L_oback:
  s_cmp_lt_u32 s77, 5
  s_cbranch_scc1 Lj_57
  s_cmp_lt_u32 s77, 7
  s_cbranch_scc1 Lj_58
  s_cmp_lt_u32 s77, 8
  s_cbranch_scc1 Lj_59
  s_cmp_lt_u32 s77, 9
  s_cbranch_scc1 Lj_60
  s_branch L_o9
Lj_60:
  s_branch L_o8
Lj_59:
  s_branch L_o7
Lj_58:
  s_cmp_lt_u32 s77, 6
  s_cbranch_scc1 Lj_61
  s_branch L_o6
Lj_61:
  s_branch L_o5
Lj_57:
  s_cmp_lt_u32 s77, 2
  s_cbranch_scc1 Lj_62
  s_cmp_lt_u32 s77, 3
  s_cbranch_scc1 Lj_63
  s_cmp_lt_u32 s77, 4
  s_cbranch_scc1 Lj_64
  s_branch L_o4
Lj_64:
  s_branch L_o3
Lj_63:
  s_branch L_o2
Lj_62:
  s_cmp_lt_u32 s77, 1
  s_cbranch_scc1 Lj_65
  s_branch L_o1
Lj_65:
  s_branch L_o0
L_odone:
  v_readlane_b32 s18, v7, 6
  s_bfe_u32 s76, s35, 0x80008
  s_min_u32 s76, s76, 6
  s_sub_u32 s76, 6, s76
  s_sub_u32 s79, 10, s77
  s_add_u32 s79, s79, s76
  s_lshl_b32 s79, s79, 3
  s_lshl_b32 s68, 63, s76
  s_and_b32 s68, s68, 63
  s_mul_i32 s68, s68, 0x10001
  s_mov_b32 s69, s68
  v_and_b32 v20, 7, v0
  v_lshlrev_b32 v20, 2, v20
  ds_read_b32 v21, v20 offset:96
  s_mul_i32 s19, s18, 0x9E3779B1
  v_mov_b32 v36, s19
  s_mov_b32 s20, 117835008
  s_mov_b32 s21, 117835009
  s_mov_b32 s22, 117835010
  s_mov_b32 s23, 117835011
  s_and_b32 s18, s18, 0xffff
  v_mov_b32 v23, s18
  v_lshrrev_b32 v20, 4, v0
  s_lshl_b32 s19, s3, 4
  v_lshl_add_u32 v20, v20, 2, s19
  s_waitcnt lgkmcnt(0)
  v_lshl_add_u32 v21, v21, 7, v20
  s_nop 1
  s_cmp_lt_u32 s76, 3
  s_cbranch_scc1 Lj_66
  s_cmp_lt_u32 s76, 5
  s_cbranch_scc1 Lj_67
  s_cmp_lt_u32 s76, 6
  s_cbranch_scc1 Lj_68
  s_branch L_p6
Lj_68:
  s_branch L_p5
Lj_67:
  s_cmp_lt_u32 s76, 4
  s_cbranch_scc1 Lj_69
  s_branch L_p4
Lj_69:
  s_branch L_p3
Lj_66:
  s_cmp_lt_u32 s76, 1
  s_cbranch_scc1 Lj_70
  s_cmp_lt_u32 s76, 2
  s_cbranch_scc1 Lj_71
  s_branch L_p2
Lj_71:
  s_branch L_p1
Lj_70:
  s_branch L_p0
L_p0:
  s_waitcnt lgkmcnt(0)
  v_readlane_b32 s17, v7, 24
  s_nop 0
  s_min_u32 s17, s17, 79
  s_lshl_b32 s17, s17, 13
  s_add_u32 s17, s17, s33
  s_sub_u32 s17, s17, 8192
  s_add_u32 s17, s17, 8192
  s_add_u32 s19, s75, 0
  s_mov_b32 m0, s19
  s_waitcnt vmcnt(4) lgkmcnt(0)
  v_readfirstlane_b32 s19, v7
  s_nop 0
  s_add_u32 s19, s19, s79
  s_cmp_ge_i32 s19, 482
  s_cbranch_scc1 Lgo_72
  s_waitcnt vmcnt(3)
  s_cmp_ge_i32 s19, 474
  s_cbranch_scc1 Lgo_72
  s_waitcnt vmcnt(2)
  s_cmp_ge_i32 s19, 466
  s_cbranch_scc1 Lgo_72
  s_waitcnt vmcnt(1)
Lgo_72:
  buffer_load_dwordx4 v2, s[12:15], s17 offen nt lds
  ds_add_rtn_u32 v7, v1, v6 offset:0
L_p1:
  s_waitcnt lgkmcnt(0)
  v_readlane_b32 s17, v7, 25
  s_nop 0
  s_min_u32 s17, s17, 79
  s_lshl_b32 s17, s17, 13
  s_add_u32 s17, s17, s33
  s_sub_u32 s17, s17, 8192
  s_add_u32 s17, s17, 8192
  s_add_u32 s19, s75, 1024
  s_mov_b32 m0, s19
  s_waitcnt vmcnt(4) lgkmcnt(0)
  v_readfirstlane_b32 s19, v7
  s_nop 0
  s_add_u32 s19, s19, s79
  s_cmp_ge_i32 s19, 486
  s_cbranch_scc1 Lgo_73
  s_waitcnt vmcnt(3)
  s_cmp_ge_i32 s19, 478
  s_cbranch_scc1 Lgo_73
  s_waitcnt vmcnt(2)
  s_cmp_ge_i32 s19, 470
  s_cbranch_scc1 Lgo_73
  s_waitcnt vmcnt(1)
Lgo_73:
  buffer_load_dwordx4 v2, s[12:15], s17 offen nt lds
  ds_add_rtn_u32 v7, v1, v6 offset:0
L_p2:
  s_waitcnt lgkmcnt(0)
  v_readlane_b32 s17, v7, 26
  s_nop 0
  s_min_u32 s17, s17, 79
  s_lshl_b32 s17, s17, 13
  s_add_u32 s17, s17, s33
  s_sub_u32 s17, s17, 8192
  s_add_u32 s17, s17, 8192
  s_add_u32 s19, s75, 2048
  s_mov_b32 m0, s19
  s_waitcnt vmcnt(4) lgkmcnt(0)
  v_readfirstlane_b32 s19, v7
  s_nop 0
  s_add_u32 s19, s19, s79
  s_cmp_ge_i32 s19, 482
  s_cbranch_scc1 Lgo_74
  s_waitcnt vmcnt(3)
  s_cmp_ge_i32 s19, 474
  s_cbranch_scc1 Lgo_74
  s_waitcnt vmcnt(2)
  s_cmp_ge_i32 s19, 466
  s_cbranch_scc1 Lgo_74
  s_waitcnt vmcnt(1)
Lgo_74:
  buffer_load_dwordx4 v2, s[12:15], s17 offen nt lds
  ds_add_rtn_u32 v7, v1, v6 offset:0
L_p3:
  s_waitcnt lgkmcnt(0)
  v_readlane_b32 s17, v7, 27
  s_nop 0
  s_min_u32 s17, s17, 79
  s_lshl_b32 s17, s17, 13
  s_add_u32 s17, s17, s33
  s_sub_u32 s17, s17, 8192
  s_add_u32 s17, s17, 8192
  s_add_u32 s19, s75, 3072
  s_mov_b32 m0, s19
  s_waitcnt vmcnt(4) lgkmcnt(0)
  v_readfirstlane_b32 s19, v7
  s_nop 0
  s_add_u32 s19, s19, s79
  s_cmp_ge_i32 s19, 486
  s_cbranch_scc1 Lgo_75
  s_waitcnt vmcnt(3)
  s_cmp_ge_i32 s19, 478
  s_cbranch_scc1 Lgo_75
  s_waitcnt vmcnt(2)
  s_cmp_ge_i32 s19, 470
  s_cbranch_scc1 Lgo_75
  s_waitcnt vmcnt(1)
Lgo_75:
  buffer_load_dwordx4 v2, s[12:15], s17 offen nt lds
  ds_add_rtn_u32 v7, v1, v6 offset:0
L_p4:
  s_waitcnt lgkmcnt(0)
  v_readlane_b32 s17, v7, 28
  s_nop 0
  s_min_u32 s17, s17, 79
  s_lshl_b32 s17, s17, 13
  s_add_u32 s17, s17, s33
  s_sub_u32 s17, s17, 8192
  s_add_u32 s17, s17, 8192
  s_add_u32 s19, s75, 4096
  s_mov_b32 m0, s19
  s_waitcnt vmcnt(4) lgkmcnt(0)
  v_readfirstlane_b32 s19, v7
  s_nop 0
  s_add_u32 s19, s19, s79
  s_cmp_ge_i32 s19, 500
  s_cbranch_scc1 Lgo_76
  s_waitcnt vmcnt(3)
  s_cmp_ge_i32 s19, 492
  s_cbranch_scc1 Lgo_76
  s_waitcnt vmcnt(2)
  s_cmp_ge_i32 s19, 484
  s_cbranch_scc1 Lgo_76
  s_waitcnt vmcnt(1)
Lgo_76:
  buffer_load_dwordx4 v2, s[12:15], s17 offen nt lds
  ds_add_rtn_u32 v7, v1, v6 offset:0
L_p5:
  s_waitcnt lgkmcnt(0)
  v_readlane_b32 s17, v7, 29
  s_nop 0
  s_min_u32 s17, s17, 79
  s_lshl_b32 s17, s17, 13
  s_add_u32 s17, s17, s33
  s_sub_u32 s17, s17, 8192
  s_add_u32 s17, s17, 8192
  s_add_u32 s19, s75, 5120
  s_mov_b32 m0, s19
  s_waitcnt vmcnt(4) lgkmcnt(0)
  v_readfirstlane_b32 s19, v7
  s_nop 0
  s_add_u32 s19, s19, s79
  s_cmp_ge_i32 s19, 504
  s_cbranch_scc1 Lgo_77
  s_waitcnt vmcnt(3)
  s_cmp_ge_i32 s19, 496
  s_cbranch_scc1 Lgo_77
  s_waitcnt vmcnt(2)
  s_cmp_ge_i32 s19, 488
  s_cbranch_scc1 Lgo_77
  s_waitcnt vmcnt(1)
Lgo_77:
  buffer_load_dwordx4 v2, s[12:15], s17 offen nt lds
  ds_add_rtn_u32 v7, v1, v6 offset:0
  s_mov_b64 exec, s[68:69]
  global_load_dword v20, v21, s[72:73] sc1
  s_mov_b64 exec, -1
L_p6:
L_p16:
  s_mov_b32 s17, s74
  s_waitcnt lgkmcnt(0)
  v_readlane_b32 s35, v7, 3
  s_nop 0
  s_cmp_eq_u32 s35, 0
  s_nop 1
  s_cbranch_scc1 L_late
  s_add_u32 s17, s17, 8192
  s_waitcnt vmcnt(4) lgkmcnt(0)
  v_readfirstlane_b32 s19, v7
  s_nop 0
  s_add_u32 s19, s19, s79
  s_cmp_ge_i32 s19, 514
  s_cbranch_scc1 Lgo_78
  s_waitcnt vmcnt(3)
  s_cmp_ge_i32 s19, 506
  s_cbranch_scc1 Lgo_78
  s_waitcnt vmcnt(2)
  s_cmp_ge_i32 s19, 498
  s_cbranch_scc1 Lgo_78
  s_waitcnt vmcnt(1)
Lgo_78:
  buffer_load_dwordx4 v[112:115], v2, s[12:15], s17 offen nt
  ds_add_rtn_u32 v7, v1, v6 offset:0
  v_mov_b32 v8, 0
  ds_read_b64 v[10:11], v8 offset:64
  ds_read_b32 v13, v8 offset:28
  s_waitcnt lgkmcnt(0)
  v_add_u32 v13, v13, v2
  v_sub_f32 v4, v4, v10
  v_sub_f32 v5, v5, v10
  v_mul_f32 v4, 1069066811, v4
  v_mul_f32 v5, 1069066811, v5
  v_exp_f32 v4, v4
  v_exp_f32 v5, v5
  v_mul_f32 v4, v4, v11
  v_mul_f32 v5, v5, v11
  v_cvt_pk_bf16_f32 v4, v4, v4
  v_cvt_pk_bf16_f32 v5, v5, v5
  s_add_u32 s17, s17, 8192
  s_waitcnt vmcnt(4) lgkmcnt(0)
  v_readfirstlane_b32 s19, v7
  s_nop 0
  s_add_u32 s19, s19, s79
  s_cmp_ge_i32 s19, 518
  s_cbranch_scc1 Lgo_79
  s_waitcnt vmcnt(3)
  s_cmp_ge_i32 s19, 510
  s_cbranch_scc1 Lgo_79
  s_waitcnt vmcnt(2)
  s_cmp_ge_i32 s19, 502
  s_cbranch_scc1 Lgo_79
  s_waitcnt vmcnt(1)
Lgo_79:
  buffer_load_dwordx4 v[116:119], v2, s[12:15], s17 offen nt
  ds_add_rtn_u32 v7, v1, v6 offset:0
  v_and_b32_dpp v28, v4, v24 row_newbcast:0 row_mask:0xf bank_mask:0xf
  v_and_b32_dpp v29, v4, v25 row_newbcast:0 row_mask:0xf bank_mask:0xf
  v_and_b32_dpp v30, v4, v26 row_newbcast:0 row_mask:0xf bank_mask:0xf
  v_and_b32_dpp v31, v4, v27 row_newbcast:0 row_mask:0xf bank_mask:0xf
  v_and_b32_dpp v32, v4, v24 row_newbcast:4 row_mask:0xf bank_mask:0xf
  v_and_b32_dpp v33, v4, v25 row_newbcast:4 row_mask:0xf bank_mask:0xf
  v_and_b32_dpp v34, v4, v26 row_newbcast:4 row_mask:0xf bank_mask:0xf
  v_and_b32_dpp v35, v4, v27 row_newbcast:4 row_mask:0xf bank_mask:0xf
  v_mfma_f32_16x16x32_bf16 v[16:19], v[28:31], v[40:43], 0
  v_and_b32_dpp v28, v4, v24 row_newbcast:8 row_mask:0xf bank_mask:0xf
  v_and_b32_dpp v29, v4, v25 row_newbcast:8 row_mask:0xf bank_mask:0xf
  v_and_b32_dpp v30, v4, v26 row_newbcast:8 row_mask:0xf bank_mask:0xf
  v_and_b32_dpp v31, v4, v27 row_newbcast:8 row_mask:0xf bank_mask:0xf
  v_mfma_f32_16x16x32_bf16 v[16:19], v[32:35], v[44:47], v[16:19]
  v_and_b32_dpp v32, v4, v24 row_newbcast:12 row_mask:0xf bank_mask:0xf
  v_and_b32_dpp v33, v4, v25 row_newbcast:12 row_mask:0xf bank_mask:0xf
  v_and_b32_dpp v34, v4, v26 row_newbcast:12 row_mask:0xf bank_mask:0xf
  v_and_b32_dpp v35, v4, v27 row_newbcast:12 row_mask:0xf bank_mask:0xf
  v_mfma_f32_16x16x32_bf16 v[16:19], v[28:31], v[48:51], v[16:19]
  v_and_b32_dpp v28, v4, v24 row_newbcast:1 row_mask:0xf bank_mask:0xf
  v_and_b32_dpp v29, v4, v25 row_newbcast:1 row_mask:0xf bank_mask:0xf
  v_and_b32_dpp v30, v4, v26 row_newbcast:1 row_mask:0xf bank_mask:0xf
  v_and_b32_dpp v31, v4, v27 row_newbcast:1 row_mask:0xf bank_mask:0xf
  v_mfma_f32_16x16x32_bf16 v[16:19], v[32:35], v[52:55], v[16:19]
  v_and_b32_dpp v32, v4, v24 row_newbcast:5 row_mask:0xf bank_mask:0xf
  v_and_b32_dpp v33, v4, v25 row_newbcast:5 row_mask:0xf bank_mask:0xf
  v_and_b32_dpp v34, v4, v26 row_newbcast:5 row_mask:0xf bank_mask:0xf
  v_and_b32_dpp v35, v4, v27 row_newbcast:5 row_mask:0xf bank_mask:0xf
  v_mfma_f32_16x16x32_bf16 v[16:19], v[28:31], v[56:59], v[16:19]
  v_and_b32_dpp v28, v4, v24 row_newbcast:9 row_mask:0xf bank_mask:0xf
  v_and_b32_dpp v29, v4, v25 row_newbcast:9 row_mask:0xf bank_mask:0xf
  v_and_b32_dpp v30, v4, v26 row_newbcast:9 row_mask:0xf bank_mask:0xf
  v_and_b32_dpp v31, v4, v27 row_newbcast:9 row_mask:0xf bank_mask:0xf
  v_mfma_f32_16x16x32_bf16 v[16:19], v[32:35], v[60:63], v[16:19]
  s_add_u32 s17, s17, 8192
  s_waitcnt vmcnt(4) lgkmcnt(0)
  v_readfirstlane_b32 s19, v7
  s_nop 0
  s_add_u32 s19, s19, s79
  s_cmp_ge_i32 s19, 532
  s_cbranch_scc1 Lgo_80
  s_waitcnt vmcnt(3)
  s_cmp_ge_i32 s19, 524
  s_cbranch_scc1 Lgo_80
  s_waitcnt vmcnt(2)
  s_cmp_ge_i32 s19, 516
  s_cbranch_scc1 Lgo_80
  s_waitcnt vmcnt(1)
Lgo_80:
  buffer_load_dwordx4 v[120:123], v2, s[12:15], s17 offen nt
  ds_add_rtn_u32 v7, v1, v6 offset:0
  v_and_b32_dpp v32, v4, v24 row_newbcast:13 row_mask:0xf bank_mask:0xf
  v_and_b32_dpp v33, v4, v25 row_newbcast:13 row_mask:0xf bank_mask:0xf
  v_and_b32_dpp v34, v4, v26 row_newbcast:13 row_mask:0xf bank_mask:0xf
  v_and_b32_dpp v35, v4, v27 row_newbcast:13 row_mask:0xf bank_mask:0xf
  v_mfma_f32_16x16x32_bf16 v[16:19], v[28:31], v[64:67], v[16:19]
  v_and_b32_dpp v28, v4, v24 row_newbcast:2 row_mask:0xf bank_mask:0xf
  v_and_b32_dpp v29, v4, v25 row_newbcast:2 row_mask:0xf bank_mask:0xf
  v_and_b32_dpp v30, v4, v26 row_newbcast:2 row_mask:0xf bank_mask:0xf
  v_and_b32_dpp v31, v4, v27 row_newbcast:2 row_mask:0xf bank_mask:0xf
  v_mfma_f32_16x16x32_bf16 v[16:19], v[32:35], v[68:71], v[16:19]
  v_and_b32_dpp v32, v4, v24 row_newbcast:6 row_mask:0xf bank_mask:0xf
  v_and_b32_dpp v33, v4, v25 row_newbcast:6 row_mask:0xf bank_mask:0xf
  v_and_b32_dpp v34, v4, v26 row_newbcast:6 row_mask:0xf bank_mask:0xf
  v_and_b32_dpp v35, v4, v27 row_newbcast:6 row_mask:0xf bank_mask:0xf
  v_mfma_f32_16x16x32_bf16 v[16:19], v[28:31], v[72:75], v[16:19]
  v_and_b32_dpp v28, v4, v24 row_newbcast:10 row_mask:0xf bank_mask:0xf
  v_and_b32_dpp v29, v4, v25 row_newbcast:10 row_mask:0xf bank_mask:0xf
  v_and_b32_dpp v30, v4, v26 row_newbcast:10 row_mask:0xf bank_mask:0xf
  v_and_b32_dpp v31, v4, v27 row_newbcast:10 row_mask:0xf bank_mask:0xf
  v_mfma_f32_16x16x32_bf16 v[16:19], v[32:35], v[76:79], v[16:19]
  v_and_b32_dpp v32, v4, v24 row_newbcast:14 row_mask:0xf bank_mask:0xf
  v_and_b32_dpp v33, v4, v25 row_newbcast:14 row_mask:0xf bank_mask:0xf
  v_and_b32_dpp v34, v4, v26 row_newbcast:14 row_mask:0xf bank_mask:0xf
  v_and_b32_dpp v35, v4, v27 row_newbcast:14 row_mask:0xf bank_mask:0xf
  v_mfma_f32_16x16x32_bf16 v[16:19], v[28:31], v[80:83], v[16:19]
  v_and_b32_dpp v28, v4, v24 row_newbcast:3 row_mask:0xf bank_mask:0xf
  v_and_b32_dpp v29, v4, v25 row_newbcast:3 row_mask:0xf bank_mask:0xf
  v_and_b32_dpp v30, v4, v26 row_newbcast:3 row_mask:0xf bank_mask:0xf
  v_and_b32_dpp v31, v4, v27 row_newbcast:3 row_mask:0xf bank_mask:0xf
  v_mfma_f32_16x16x32_bf16 v[16:19], v[32:35], v[84:87], v[16:19]
  v_and_b32_dpp v32, v4, v24 row_newbcast:7 row_mask:0xf bank_mask:0xf
  v_and_b32_dpp v33, v4, v25 row_newbcast:7 row_mask:0xf bank_mask:0xf
  v_and_b32_dpp v34, v4, v26 row_newbcast:7 row_mask:0xf bank_mask:0xf
  v_and_b32_dpp v35, v4, v27 row_newbcast:7 row_mask:0xf bank_mask:0xf
  v_mfma_f32_16x16x32_bf16 v[16:19], v[28:31], v[88:91], v[16:19]
  s_add_u32 s17, s17, 8192
  s_waitcnt vmcnt(4) lgkmcnt(0)
  v_readfirstlane_b32 s19, v7
  s_nop 0
  s_add_u32 s19, s19, s79
  s_cmp_ge_i32 s19, 536
  s_cbranch_scc1 Lgo_81
  s_waitcnt vmcnt(3)
  s_cmp_ge_i32 s19, 528
  s_cbranch_scc1 Lgo_81
  s_waitcnt vmcnt(2)
  s_cmp_ge_i32 s19, 520
  s_cbranch_scc1 Lgo_81
  s_waitcnt vmcnt(1)
Lgo_81:
  buffer_load_dwordx4 v[124:127], v2, s[12:15], s17 offen nt
  ds_add_rtn_u32 v7, v1, v6 offset:0
  s_branch L_join
L_late:
  s_add_u32 s17, s17, 8192
  s_waitcnt vmcnt(4) lgkmcnt(0)
  v_readfirstlane_b32 s19, v7
  s_nop 0
  s_add_u32 s19, s19, s79
  s_cmp_ge_i32 s19, 514
  s_cbranch_scc1 Lgo_82
  s_waitcnt vmcnt(3)
  s_cmp_ge_i32 s19, 506
  s_cbranch_scc1 Lgo_82
  s_waitcnt vmcnt(2)
  s_cmp_ge_i32 s19, 498
  s_cbranch_scc1 Lgo_82
  s_waitcnt vmcnt(1)
Lgo_82:
  buffer_load_dwordx4 v[112:115], v2, s[12:15], s17 offen nt
  ds_add_rtn_u32 v7, v1, v6 offset:0
  s_add_u32 s17, s17, 8192
  s_waitcnt vmcnt(4) lgkmcnt(0)
  v_readfirstlane_b32 s19, v7
  s_nop 0
  s_add_u32 s19, s19, s79
  s_cmp_ge_i32 s19, 518
  s_cbranch_scc1 Lgo_83
  s_waitcnt vmcnt(3)
  s_cmp_ge_i32 s19, 510
  s_cbranch_scc1 Lgo_83
  s_waitcnt vmcnt(2)
  s_cmp_ge_i32 s19, 502
  s_cbranch_scc1 Lgo_83
  s_waitcnt vmcnt(1)
Lgo_83:
  buffer_load_dwordx4 v[116:119], v2, s[12:15], s17 offen nt
  ds_add_rtn_u32 v7, v1, v6 offset:0
  s_add_u32 s17, s17, 8192
  s_waitcnt vmcnt(4) lgkmcnt(0)
  v_readfirstlane_b32 s19, v7
  s_nop 0
  s_add_u32 s19, s19, s79
  s_cmp_ge_i32 s19, 532
  s_cbranch_scc1 Lgo_84
  s_waitcnt vmcnt(3)
  s_cmp_ge_i32 s19, 524
  s_cbranch_scc1 Lgo_84
  s_waitcnt vmcnt(2)
  s_cmp_ge_i32 s19, 516
  s_cbranch_scc1 Lgo_84
  s_waitcnt vmcnt(1)
Lgo_84:
  buffer_load_dwordx4 v[120:123], v2, s[12:15], s17 offen nt
  ds_add_rtn_u32 v7, v1, v6 offset:0
  s_add_u32 s17, s17, 8192
  s_waitcnt vmcnt(4) lgkmcnt(0)
  v_readfirstlane_b32 s19, v7
  s_nop 0
  s_add_u32 s19, s19, s79
  s_cmp_ge_i32 s19, 536
  s_cbranch_scc1 Lgo_85
  s_waitcnt vmcnt(3)
  s_cmp_ge_i32 s19, 528
  s_cbranch_scc1 Lgo_85
  s_waitcnt vmcnt(2)
  s_cmp_ge_i32 s19, 520
  s_cbranch_scc1 Lgo_85
  s_waitcnt vmcnt(1)
Lgo_85:
  buffer_load_dwordx4 v[124:127], v2, s[12:15], s17 offen nt
  ds_add_rtn_u32 v7, v1, v6 offset:0
  v_mov_b32 v8, 0
  s_mov_b32 s34, 0
Lw_86:
  ds_read_b32 v9, v8 offset:12
  s_waitcnt lgkmcnt(0)
  v_readfirstlane_b32 s35, v9
  s_nop 0
  s_cmp_eq_u32 s35, 1
  s_nop 1
  s_cbranch_scc1 Lwe_87
  s_sleep 1
  s_add_u32 s34, s34, 1
  s_cmp_lt_u32 s34, 800000
  s_cbranch_scc1 Lw_86
Lwe_87:
  ds_read_b64 v[10:11], v8 offset:64
  ds_read_b32 v13, v8 offset:28
  s_waitcnt lgkmcnt(0)
  v_add_u32 v13, v13, v2
  v_sub_f32 v4, v4, v10
  v_sub_f32 v5, v5, v10
  v_mul_f32 v4, 1069066811, v4
  v_mul_f32 v5, 1069066811, v5
  v_exp_f32 v4, v4
  v_exp_f32 v5, v5
  v_mul_f32 v4, v4, v11
  v_mul_f32 v5, v5, v11
  v_cvt_pk_bf16_f32 v4, v4, v4
  v_cvt_pk_bf16_f32 v5, v5, v5
  s_nop 0
  v_and_b32_dpp v28, v4, v24 row_newbcast:0 row_mask:0xf bank_mask:0xf
  v_and_b32_dpp v29, v4, v25 row_newbcast:0 row_mask:0xf bank_mask:0xf
  v_and_b32_dpp v30, v4, v26 row_newbcast:0 row_mask:0xf bank_mask:0xf
  v_and_b32_dpp v31, v4, v27 row_newbcast:0 row_mask:0xf bank_mask:0xf
  v_and_b32_dpp v32, v4, v24 row_newbcast:4 row_mask:0xf bank_mask:0xf
  v_and_b32_dpp v33, v4, v25 row_newbcast:4 row_mask:0xf bank_mask:0xf
  v_and_b32_dpp v34, v4, v26 row_newbcast:4 row_mask:0xf bank_mask:0xf
  v_and_b32_dpp v35, v4, v27 row_newbcast:4 row_mask:0xf bank_mask:0xf
  v_mfma_f32_16x16x32_bf16 v[16:19], v[28:31], v[40:43], 0
  v_and_b32_dpp v28, v4, v24 row_newbcast:8 row_mask:0xf bank_mask:0xf
  v_and_b32_dpp v29, v4, v25 row_newbcast:8 row_mask:0xf bank_mask:0xf
  v_and_b32_dpp v30, v4, v26 row_newbcast:8 row_mask:0xf bank_mask:0xf
  v_and_b32_dpp v31, v4, v27 row_newbcast:8 row_mask:0xf bank_mask:0xf
  v_mfma_f32_16x16x32_bf16 v[16:19], v[32:35], v[44:47], v[16:19]
  v_and_b32_dpp v32, v4, v24 row_newbcast:12 row_mask:0xf bank_mask:0xf
  v_and_b32_dpp v33, v4, v25 row_newbcast:12 row_mask:0xf bank_mask:0xf
  v_and_b32_dpp v34, v4, v26 row_newbcast:12 row_mask:0xf bank_mask:0xf
  v_and_b32_dpp v35, v4, v27 row_newbcast:12 row_mask:0xf bank_mask:0xf
  v_mfma_f32_16x16x32_bf16 v[16:19], v[28:31], v[48:51], v[16:19]
  v_and_b32_dpp v28, v4, v24 row_newbcast:1 row_mask:0xf bank_mask:0xf
  v_and_b32_dpp v29, v4, v25 row_newbcast:1 row_mask:0xf bank_mask:0xf
  v_and_b32_dpp v30, v4, v26 row_newbcast:1 row_mask:0xf bank_mask:0xf
  v_and_b32_dpp v31, v4, v27 row_newbcast:1 row_mask:0xf bank_mask:0xf
  v_mfma_f32_16x16x32_bf16 v[16:19], v[32:35], v[52:55], v[16:19]
  v_and_b32_dpp v32, v4, v24 row_newbcast:5 row_mask:0xf bank_mask:0xf
  v_and_b32_dpp v33, v4, v25 row_newbcast:5 row_mask:0xf bank_mask:0xf
  v_and_b32_dpp v34, v4, v26 row_newbcast:5 row_mask:0xf bank_mask:0xf
  v_and_b32_dpp v35, v4, v27 row_newbcast:5 row_mask:0xf bank_mask:0xf
  v_mfma_f32_16x16x32_bf16 v[16:19], v[28:31], v[56:59], v[16:19]
  v_and_b32_dpp v28, v4, v24 row_newbcast:9 row_mask:0xf bank_mask:0xf
  v_and_b32_dpp v29, v4, v25 row_newbcast:9 row_mask:0xf bank_mask:0xf
  v_and_b32_dpp v30, v4, v26 row_newbcast:9 row_mask:0xf bank_mask:0xf
  v_and_b32_dpp v31, v4, v27 row_newbcast:9 row_mask:0xf bank_mask:0xf
  v_mfma_f32_16x16x32_bf16 v[16:19], v[32:35], v[60:63], v[16:19]
  v_and_b32_dpp v32, v4, v24 row_newbcast:13 row_mask:0xf bank_mask:0xf
  v_and_b32_dpp v33, v4, v25 row_newbcast:13 row_mask:0xf bank_mask:0xf
  v_and_b32_dpp v34, v4, v26 row_newbcast:13 row_mask:0xf bank_mask:0xf
  v_and_b32_dpp v35, v4, v27 row_newbcast:13 row_mask:0xf bank_mask:0xf
  v_mfma_f32_16x16x32_bf16 v[16:19], v[28:31], v[64:67], v[16:19]
  v_and_b32_dpp v28, v4, v24 row_newbcast:2 row_mask:0xf bank_mask:0xf
  v_and_b32_dpp v29, v4, v25 row_newbcast:2 row_mask:0xf bank_mask:0xf
  v_and_b32_dpp v30, v4, v26 row_newbcast:2 row_mask:0xf bank_mask:0xf
  v_and_b32_dpp v31, v4, v27 row_newbcast:2 row_mask:0xf bank_mask:0xf
  v_mfma_f32_16x16x32_bf16 v[16:19], v[32:35], v[68:71], v[16:19]
  v_and_b32_dpp v32, v4, v24 row_newbcast:6 row_mask:0xf bank_mask:0xf
  v_and_b32_dpp v33, v4, v25 row_newbcast:6 row_mask:0xf bank_mask:0xf
  v_and_b32_dpp v34, v4, v26 row_newbcast:6 row_mask:0xf bank_mask:0xf
  v_and_b32_dpp v35, v4, v27 row_newbcast:6 row_mask:0xf bank_mask:0xf
  v_mfma_f32_16x16x32_bf16 v[16:19], v[28:31], v[72:75], v[16:19]
  v_and_b32_dpp v28, v4, v24 row_newbcast:10 row_mask:0xf bank_mask:0xf
  v_and_b32_dpp v29, v4, v25 row_newbcast:10 row_mask:0xf bank_mask:0xf
  v_and_b32_dpp v30, v4, v26 row_newbcast:10 row_mask:0xf bank_mask:0xf
  v_and_b32_dpp v31, v4, v27 row_newbcast:10 row_mask:0xf bank_mask:0xf
  v_mfma_f32_16x16x32_bf16 v[16:19], v[32:35], v[76:79], v[16:19]
  v_and_b32_dpp v32, v4, v24 row_newbcast:14 row_mask:0xf bank_mask:0xf
  v_and_b32_dpp v33, v4, v25 row_newbcast:14 row_mask:0xf bank_mask:0xf
  v_and_b32_dpp v34, v4, v26 row_newbcast:14 row_mask:0xf bank_mask:0xf
  v_and_b32_dpp v35, v4, v27 row_newbcast:14 row_mask:0xf bank_mask:0xf
  v_mfma_f32_16x16x32_bf16 v[16:19], v[28:31], v[80:83], v[16:19]
  v_and_b32_dpp v28, v4, v24 row_newbcast:3 row_mask:0xf bank_mask:0xf
  v_and_b32_dpp v29, v4, v25 row_newbcast:3 row_mask:0xf bank_mask:0xf
  v_and_b32_dpp v30, v4, v26 row_newbcast:3 row_mask:0xf bank_mask:0xf
  v_and_b32_dpp v31, v4, v27 row_newbcast:3 row_mask:0xf bank_mask:0xf
  v_mfma_f32_16x16x32_bf16 v[16:19], v[32:35], v[84:87], v[16:19]
  v_and_b32_dpp v32, v4, v24 row_newbcast:7 row_mask:0xf bank_mask:0xf
  v_and_b32_dpp v33, v4, v25 row_newbcast:7 row_mask:0xf bank_mask:0xf
  v_and_b32_dpp v34, v4, v26 row_newbcast:7 row_mask:0xf bank_mask:0xf
  v_and_b32_dpp v35, v4, v27 row_newbcast:7 row_mask:0xf bank_mask:0xf
  v_mfma_f32_16x16x32_bf16 v[16:19], v[28:31], v[88:91], v[16:19]
L_join:
  s_mov_b32 s34, 0
  s_mov_b64 exec, s[68:69]
  s_waitcnt vmcnt(4)
Lsd_88:
  v_xor_b32 v22, v20, v23
  v_and_b32 v12, 0xffff, v22
  v_cmp_ne_u32 vcc, 0, v12
  s_nop 0
  s_cmp_eq_u64 vcc, 0
  s_nop 1
  s_cbranch_scc1 Lsdo_89
  s_mov_b32 s78, s34
  v_mov_b32 v8, 0
  s_mov_b32 s34, 0
Lw_90:
  ds_read_b32 v9, v8 offset:48
  s_waitcnt lgkmcnt(0)
  v_readfirstlane_b32 s35, v9
  s_nop 0
  s_cmp_eq_u32 s35, 1
  s_nop 1
  s_cbranch_scc1 Lwe_91
  s_sleep 1
  s_add_u32 s34, s34, 1
  s_cmp_lt_u32 s34, 800000
  s_cbranch_scc1 Lw_90
Lwe_91:
  s_mov_b32 s34, s78
  global_load_dword v20, v21, s[72:73] sc1
  s_waitcnt vmcnt(0)
  s_cmp_lt_u32 s34, 2
  s_cbranch_scc1 Lsb_92
  s_sleep 127
Lsb_92:
  s_add_u32 s34, s34, 1
  s_cmp_lt_u32 s34, 200000
  s_cbranch_scc1 Lsd_88
Lsdo_89:
  s_mov_b64 exec, -1
  v_sub_f32 v22, v22, v10
  v_mul_f32 v22, 1069066811, v22
  v_exp_f32 v22, v22
  s_nop 0
  v_mul_f32 v22, v22, v11
  v_cvt_pk_bf16_f32 v22, v22, v22
  s_mov_b64 exec, -1
  v_add_u32 v12, s75, v2
  s_cmp_gt_u32 s76, 5
  s_cbranch_scc1 Lcp_93
  ds_read_b128 v[60:63], v12 offset:5120
  s_cmp_gt_u32 s76, 4
  s_cbranch_scc1 Lcp_93
  ds_read_b128 v[56:59], v12 offset:4096
  s_cmp_gt_u32 s76, 3
  s_cbranch_scc1 Lcp_93
  ds_read_b128 v[52:55], v12 offset:3072
  s_cmp_gt_u32 s76, 2
  s_cbranch_scc1 Lcp_93
  ds_read_b128 v[48:51], v12 offset:2048
  s_cmp_gt_u32 s76, 1
  s_cbranch_scc1 Lcp_93
  ds_read_b128 v[44:47], v12 offset:1024
  s_cmp_gt_u32 s76, 0
  s_cbranch_scc1 Lcp_93
  ds_read_b128 v[40:43], v12 offset:0
Lcp_93:
  v_mov_b32 v8, 0
  v_mov_b32 v9, 1
  v_and_b32_dpp v28, v4, v24 row_newbcast:11 row_mask:0xf bank_mask:0xf
  v_and_b32_dpp v29, v4, v25 row_newbcast:11 row_mask:0xf bank_mask:0xf
  v_and_b32_dpp v30, v4, v26 row_newbcast:11 row_mask:0xf bank_mask:0xf
  v_and_b32_dpp v31, v4, v27 row_newbcast:11 row_mask:0xf bank_mask:0xf
  v_mfma_f32_16x16x32_bf16 v[16:19], v[32:35], v[92:95], v[16:19]
  v_and_b32_dpp v32, v4, v24 row_newbcast:15 row_mask:0xf bank_mask:0xf
  v_and_b32_dpp v33, v4, v25 row_newbcast:15 row_mask:0xf bank_mask:0xf
  v_and_b32_dpp v34, v4, v26 row_newbcast:15 row_mask:0xf bank_mask:0xf
  v_and_b32_dpp v35, v4, v27 row_newbcast:15 row_mask:0xf bank_mask:0xf
  v_mfma_f32_16x16x32_bf16 v[16:19], v[28:31], v[96:99], v[16:19]
  v_and_b32_dpp v28, v5, v24 row_newbcast:0 row_mask:0xf bank_mask:0xf
  v_and_b32_dpp v29, v5, v25 row_newbcast:0 row_mask:0xf bank_mask:0xf
  v_and_b32_dpp v30, v5, v26 row_newbcast:0 row_mask:0xf bank_mask:0xf
  v_and_b32_dpp v31, v5, v27 row_newbcast:0 row_mask:0xf bank_mask:0xf
  v_mfma_f32_16x16x32_bf16 v[16:19], v[32:35], v[100:103], v[16:19]
  v_and_b32_dpp v32, v5, v24 row_newbcast:4 row_mask:0xf bank_mask:0xf
  v_and_b32_dpp v33, v5, v25 row_newbcast:4 row_mask:0xf bank_mask:0xf
  v_and_b32_dpp v34, v5, v26 row_newbcast:4 row_mask:0xf bank_mask:0xf
  v_and_b32_dpp v35, v5, v27 row_newbcast:4 row_mask:0xf bank_mask:0xf
  v_mfma_f32_16x16x32_bf16 v[16:19], v[28:31], v[104:107], v[16:19]
  s_nop 0
  v_mfma_f32_16x16x32_bf16 v[16:19], v[32:35], v[108:111], v[16:19]
  s_cmp_lt_u32 s77, 5
  s_cbranch_scc1 Lj_94
  s_cmp_lt_u32 s77, 8
  s_cbranch_scc1 Lj_95
  s_cmp_lt_u32 s77, 9
  s_cbranch_scc1 Lj_96
  s_cmp_lt_u32 s77, 10
  s_cbranch_scc1 Lj_97
  s_branch L_r10
Lj_97:
  s_branch L_r9
Lj_96:
  s_branch L_r8
Lj_95:
  s_cmp_lt_u32 s77, 6
  s_cbranch_scc1 Lj_98
  s_cmp_lt_u32 s77, 7
  s_cbranch_scc1 Lj_99
  s_branch L_r7
Lj_99:
  s_branch L_r6
Lj_98:
  s_branch L_r5
Lj_94:
  s_cmp_lt_u32 s77, 2
  s_cbranch_scc1 Lj_100
  s_cmp_lt_u32 s77, 3
  s_cbranch_scc1 Lj_101
  s_cmp_lt_u32 s77, 4
  s_cbranch_scc1 Lj_102
  s_branch L_r4
Lj_102:
  s_branch L_r3
Lj_101:
  s_branch L_r2
Lj_100:
  s_cmp_lt_u32 s77, 1
  s_cbranch_scc1 Lj_103
  s_branch L_r1
Lj_103:
  s_branch L_r0
L_r10:
  v_and_b32_dpp v32, v5, v24 row_newbcast:15 row_mask:0xf bank_mask:0xf
  v_and_b32_dpp v33, v5, v25 row_newbcast:15 row_mask:0xf bank_mask:0xf
  v_and_b32_dpp v34, v5, v26 row_newbcast:15 row_mask:0xf bank_mask:0xf
  v_and_b32_dpp v35, v5, v27 row_newbcast:15 row_mask:0xf bank_mask:0xf
  s_nop 1
  v_mfma_f32_16x16x32_bf16 v[16:19], v[32:35], v[164:167], v[16:19]
L_r9:
  v_and_b32_dpp v28, v5, v24 row_newbcast:11 row_mask:0xf bank_mask:0xf
  v_and_b32_dpp v29, v5, v25 row_newbcast:11 row_mask:0xf bank_mask:0xf
  v_and_b32_dpp v30, v5, v26 row_newbcast:11 row_mask:0xf bank_mask:0xf
  v_and_b32_dpp v31, v5, v27 row_newbcast:11 row_mask:0xf bank_mask:0xf
  s_nop 1
  v_mfma_f32_16x16x32_bf16 v[16:19], v[28:31], v[160:163], v[16:19]
L_r8:
  v_and_b32_dpp v32, v5, v24 row_newbcast:7 row_mask:0xf bank_mask:0xf
  v_and_b32_dpp v33, v5, v25 row_newbcast:7 row_mask:0xf bank_mask:0xf
  v_and_b32_dpp v34, v5, v26 row_newbcast:7 row_mask:0xf bank_mask:0xf
  v_and_b32_dpp v35, v5, v27 row_newbcast:7 row_mask:0xf bank_mask:0xf
  s_nop 1
  v_mfma_f32_16x16x32_bf16 v[16:19], v[32:35], v[156:159], v[16:19]
L_r7:
  v_and_b32_dpp v28, v5, v24 row_newbcast:3 row_mask:0xf bank_mask:0xf
  v_and_b32_dpp v29, v5, v25 row_newbcast:3 row_mask:0xf bank_mask:0xf
  v_and_b32_dpp v30, v5, v26 row_newbcast:3 row_mask:0xf bank_mask:0xf
  v_and_b32_dpp v31, v5, v27 row_newbcast:3 row_mask:0xf bank_mask:0xf
  s_nop 1
  v_mfma_f32_16x16x32_bf16 v[16:19], v[28:31], v[152:155], v[16:19]
L_r6:
  v_and_b32_dpp v32, v5, v24 row_newbcast:14 row_mask:0xf bank_mask:0xf
  v_and_b32_dpp v33, v5, v25 row_newbcast:14 row_mask:0xf bank_mask:0xf
  v_and_b32_dpp v34, v5, v26 row_newbcast:14 row_mask:0xf bank_mask:0xf
  v_and_b32_dpp v35, v5, v27 row_newbcast:14 row_mask:0xf bank_mask:0xf
  s_nop 1
  v_mfma_f32_16x16x32_bf16 v[16:19], v[32:35], v[148:151], v[16:19]
L_r5:
  v_and_b32_dpp v28, v5, v24 row_newbcast:10 row_mask:0xf bank_mask:0xf
  v_and_b32_dpp v29, v5, v25 row_newbcast:10 row_mask:0xf bank_mask:0xf
  v_and_b32_dpp v30, v5, v26 row_newbcast:10 row_mask:0xf bank_mask:0xf
  v_and_b32_dpp v31, v5, v27 row_newbcast:10 row_mask:0xf bank_mask:0xf
  s_nop 1
  v_mfma_f32_16x16x32_bf16 v[16:19], v[28:31], v[144:147], v[16:19]
L_r4:
  v_and_b32_dpp v32, v5, v24 row_newbcast:6 row_mask:0xf bank_mask:0xf
  v_and_b32_dpp v33, v5, v25 row_newbcast:6 row_mask:0xf bank_mask:0xf
  v_and_b32_dpp v34, v5, v26 row_newbcast:6 row_mask:0xf bank_mask:0xf
  v_and_b32_dpp v35, v5, v27 row_newbcast:6 row_mask:0xf bank_mask:0xf
  s_nop 1
  v_mfma_f32_16x16x32_bf16 v[16:19], v[32:35], v[140:143], v[16:19]
L_r3:
  v_and_b32_dpp v28, v5, v24 row_newbcast:2 row_mask:0xf bank_mask:0xf
  v_and_b32_dpp v29, v5, v25 row_newbcast:2 row_mask:0xf bank_mask:0xf
  v_and_b32_dpp v30, v5, v26 row_newbcast:2 row_mask:0xf bank_mask:0xf
  v_and_b32_dpp v31, v5, v27 row_newbcast:2 row_mask:0xf bank_mask:0xf
  s_nop 1
  v_mfma_f32_16x16x32_bf16 v[16:19], v[28:31], v[136:139], v[16:19]
L_r2:
  v_and_b32_dpp v32, v5, v24 row_newbcast:13 row_mask:0xf bank_mask:0xf
  v_and_b32_dpp v33, v5, v25 row_newbcast:13 row_mask:0xf bank_mask:0xf
  v_and_b32_dpp v34, v5, v26 row_newbcast:13 row_mask:0xf bank_mask:0xf
  v_and_b32_dpp v35, v5, v27 row_newbcast:13 row_mask:0xf bank_mask:0xf
  s_nop 1
  v_mfma_f32_16x16x32_bf16 v[16:19], v[32:35], v[132:135], v[16:19]
L_r1:
  v_and_b32_dpp v28, v5, v24 row_newbcast:9 row_mask:0xf bank_mask:0xf
  v_and_b32_dpp v29, v5, v25 row_newbcast:9 row_mask:0xf bank_mask:0xf
  v_and_b32_dpp v30, v5, v26 row_newbcast:9 row_mask:0xf bank_mask:0xf
  v_and_b32_dpp v31, v5, v27 row_newbcast:9 row_mask:0xf bank_mask:0xf
  s_nop 1
  v_mfma_f32_16x16x32_bf16 v[16:19], v[28:31], v[128:131], v[16:19]
L_r0:
  s_waitcnt lgkmcnt(0)
  s_cmp_lt_u32 s76, 3
  s_cbranch_scc1 Lj_104
  s_cmp_lt_u32 s76, 5
  s_cbranch_scc1 Lj_105
  s_cmp_lt_u32 s76, 6
  s_cbranch_scc1 Lj_106
  s_branch L_q6
Lj_106:
  s_branch L_q5
Lj_105:
  s_cmp_lt_u32 s76, 4
  s_cbranch_scc1 Lj_107
  s_branch L_q4
Lj_107:
  s_branch L_q3
Lj_104:
  s_cmp_lt_u32 s76, 1
  s_cbranch_scc1 Lj_108
  s_cmp_lt_u32 s76, 2
  s_cbranch_scc1 Lj_109
  s_branch L_q2
Lj_109:
  s_branch L_q1
Lj_108:
  s_branch L_q0
L_q0:
  v_and_b32_dpp v28, v22, v24 row_newbcast:0 row_mask:0xf bank_mask:0xf
  v_and_b32_dpp v29, v22, v25 row_newbcast:0 row_mask:0xf bank_mask:0xf
  v_and_b32_dpp v30, v22, v26 row_newbcast:0 row_mask:0xf bank_mask:0xf
  v_and_b32_dpp v31, v22, v27 row_newbcast:0 row_mask:0xf bank_mask:0xf
  s_nop 1
  v_mfma_f32_16x16x32_bf16 v[16:19], v[28:31], v[40:43], v[16:19]
L_q1:
  v_and_b32_dpp v32, v22, v24 row_newbcast:1 row_mask:0xf bank_mask:0xf
  v_and_b32_dpp v33, v22, v25 row_newbcast:1 row_mask:0xf bank_mask:0xf
  v_and_b32_dpp v34, v22, v26 row_newbcast:1 row_mask:0xf bank_mask:0xf
  v_and_b32_dpp v35, v22, v27 row_newbcast:1 row_mask:0xf bank_mask:0xf
  s_nop 1
  v_mfma_f32_16x16x32_bf16 v[16:19], v[32:35], v[44:47], v[16:19]
L_q2:
  v_and_b32_dpp v28, v22, v24 row_newbcast:2 row_mask:0xf bank_mask:0xf
  v_and_b32_dpp v29, v22, v25 row_newbcast:2 row_mask:0xf bank_mask:0xf
  v_and_b32_dpp v30, v22, v26 row_newbcast:2 row_mask:0xf bank_mask:0xf
  v_and_b32_dpp v31, v22, v27 row_newbcast:2 row_mask:0xf bank_mask:0xf
  s_nop 1
  v_mfma_f32_16x16x32_bf16 v[16:19], v[28:31], v[48:51], v[16:19]
L_q3:
  v_and_b32_dpp v32, v22, v24 row_newbcast:3 row_mask:0xf bank_mask:0xf
  v_and_b32_dpp v33, v22, v25 row_newbcast:3 row_mask:0xf bank_mask:0xf
  v_and_b32_dpp v34, v22, v26 row_newbcast:3 row_mask:0xf bank_mask:0xf
  v_and_b32_dpp v35, v22, v27 row_newbcast:3 row_mask:0xf bank_mask:0xf
  s_nop 1
  v_mfma_f32_16x16x32_bf16 v[16:19], v[32:35], v[52:55], v[16:19]
L_q4:
  v_and_b32_dpp v28, v22, v24 row_newbcast:4 row_mask:0xf bank_mask:0xf
  v_and_b32_dpp v29, v22, v25 row_newbcast:4 row_mask:0xf bank_mask:0xf
  v_and_b32_dpp v30, v22, v26 row_newbcast:4 row_mask:0xf bank_mask:0xf
  v_and_b32_dpp v31, v22, v27 row_newbcast:4 row_mask:0xf bank_mask:0xf
  s_nop 1
  v_mfma_f32_16x16x32_bf16 v[16:19], v[28:31], v[56:59], v[16:19]
L_q5:
  v_and_b32_dpp v32, v22, v24 row_newbcast:5 row_mask:0xf bank_mask:0xf
  v_and_b32_dpp v33, v22, v25 row_newbcast:5 row_mask:0xf bank_mask:0xf
  v_and_b32_dpp v34, v22, v26 row_newbcast:5 row_mask:0xf bank_mask:0xf
  v_and_b32_dpp v35, v22, v27 row_newbcast:5 row_mask:0xf bank_mask:0xf
  s_nop 1
  v_mfma_f32_16x16x32_bf16 v[16:19], v[32:35], v[60:63], v[16:19]
L_q6:
L_q16:
  v_and_b32_dpp v28, v5, v24 row_newbcast:8 row_mask:0xf bank_mask:0xf
  v_and_b32_dpp v29, v5, v25 row_newbcast:8 row_mask:0xf bank_mask:0xf
  v_and_b32_dpp v30, v5, v26 row_newbcast:8 row_mask:0xf bank_mask:0xf
  v_and_b32_dpp v31, v5, v27 row_newbcast:8 row_mask:0xf bank_mask:0xf
  v_and_b32_dpp v32, v5, v24 row_newbcast:12 row_mask:0xf bank_mask:0xf
  v_and_b32_dpp v33, v5, v25 row_newbcast:12 row_mask:0xf bank_mask:0xf
  v_and_b32_dpp v34, v5, v26 row_newbcast:12 row_mask:0xf bank_mask:0xf
  v_and_b32_dpp v35, v5, v27 row_newbcast:12 row_mask:0xf bank_mask:0xf
  s_waitcnt vmcnt(3)
  v_mfma_f32_16x16x32_bf16 v[16:19], v[28:31], v[112:115], v[16:19]
  v_and_b32_dpp v28, v5, v24 row_newbcast:1 row_mask:0xf bank_mask:0xf
  v_and_b32_dpp v29, v5, v25 row_newbcast:1 row_mask:0xf bank_mask:0xf
  v_and_b32_dpp v30, v5, v26 row_newbcast:1 row_mask:0xf bank_mask:0xf
  v_and_b32_dpp v31, v5, v27 row_newbcast:1 row_mask:0xf bank_mask:0xf
  s_waitcnt vmcnt(2)
  v_mfma_f32_16x16x32_bf16 v[16:19], v[32:35], v[116:119], v[16:19]
  v_and_b32_dpp v32, v5, v24 row_newbcast:5 row_mask:0xf bank_mask:0xf
  v_and_b32_dpp v33, v5, v25 row_newbcast:5 row_mask:0xf bank_mask:0xf
  v_and_b32_dpp v34, v5, v26 row_newbcast:5 row_mask:0xf bank_mask:0xf
  v_and_b32_dpp v35, v5, v27 row_newbcast:5 row_mask:0xf bank_mask:0xf
  s_waitcnt vmcnt(1)
  v_mfma_f32_16x16x32_bf16 v[16:19], v[28:31], v[120:123], v[16:19]
  s_waitcnt vmcnt(0)
  v_mfma_f32_16x16x32_bf16 v[16:19], v[32:35], v[124:127], v[16:19]
  s_mov_b32 exec_hi, 0
  s_nop 6
  ds_write_b128 v14, v[16:19] offset:512
  s_mov_b32 exec_lo, 1
  ds_add_rtn_u32 v10, v1, v6 offset:16
  s_mov_b64 exec, -1
  ds_read_b128 v[40:43], v2 offset:512
  ds_read_b128 v[44:47], v2 offset:1536
  ds_read_b128 v[48:51], v2 offset:2560
  ds_read_b128 v[52:55], v2 offset:3584
  s_waitcnt lgkmcnt(4)
  v_readfirstlane_b32 s18, v10
  s_nop 0
  s_cmp_lg_u32 s18, 7
  s_cbranch_scc1 L_send
  s_waitcnt lgkmcnt(0)
  v_pk_add_f32 v[40:41], v[40:41], v[44:45]
  v_pk_add_f32 v[48:49], v[48:49], v[52:53]
  v_pk_add_f32 v[42:43], v[42:43], v[46:47]
  v_pk_add_f32 v[50:51], v[50:51], v[54:55]
  v_pk_add_f32 v[40:41], v[40:41], v[48:49]
  v_pk_add_f32 v[42:43], v[42:43], v[50:51]
  s_nop 0
  v_permlane32_swap_b32 v40, v48
  v_permlane32_swap_b32 v41, v49
  v_permlane32_swap_b32 v42, v50
  v_permlane32_swap_b32 v43, v51
  v_pk_add_f32 v[40:41], v[40:41], v[48:49]
  v_pk_add_f32 v[42:43], v[42:43], v[50:51]
  s_mov_b32 exec_hi, 0
  v_perm_b32 v40, v40, v36, s20
  v_perm_b32 v41, v41, v36, s21
  v_perm_b32 v42, v42, v36, s22
  v_perm_b32 v43, v43, v36, s23
  global_store_dwordx4 v13, v[40:43], s[64:65] sc1
  s_mov_b64 exec, 1
  ds_add_u32 v8, v9 offset:16
  s_mov_b32 exec_lo, -1
L_send:
  s_endpgm
L_help:
  s_lshl_b32 s4, s5, 3
  s_add_u32 s4, s4, s6
  s_and_b32 s100, s7, 3
  s_lshl_b32 s16, s100, 3
  s_add_u32 s16, s16, s5
  s_and_b32 s16, s16, 31
  s_lshr_b32 s7, s16, 1
  s_lshl_b32 s7, s7, 3
  s_lshl_b32 s17, s100, 1
  s_add_u32 s7, s7, s17
  s_and_b32 s17, s16, 1
  s_add_u32 s7, s7, s17
  s_mov_b32 s17, 4335644
  s_cmp_eq_u32 s100, 1
  s_cselect_b32 s17, 5505044, s17
  s_cmp_eq_u32 s100, 2
  s_cselect_b32 s17, 4736026, s17
  s_cmp_eq_u32 s100, 3
  s_cselect_b32 s17, 6296596, s17
  s_and_b32 s18, s17, 0xff
  s_bfe_u32 s19, s17, 0x80008
  s_lshr_b32 s17, s17, 16
  s_cmp_lt_u32 s16, s18
  s_cselect_b32 s17, s19, s17
  s_add_u32 s17, s17, s16
  s_bitcmp1_b32 s2, 2
  s_cselect_b32 s7, s7, s17
  s_cmp_lt_u32 s7, 94
  s_cselect_b32 s33, 2, 3
  s_cmp_lt_u32 s7, 40
  s_cselect_b32 s33, 1, s33
  s_bitcmp1_b32 s2, 2
  s_cselect_b32 s33, 0, s33
  s_mov_b32 s0, 0
  s_cmp_eq_u32 s3, 3
  s_cbranch_scc1 L_h3
  s_cmp_lg_u32 s33, 0
  s_cbranch_scc1 L_h2
  s_cmp_lg_u32 s3, 0
  s_cbranch_scc1 L_h1
  s_mov_b32 s21, s7
  s_mov_b32 s23, 0
L_h0_unit:
  s_mul_i32 s16, s21, 52429
  s_lshr_b32 s16, s16, 20
  s_mul_i32 s17, s16, 20
  s_sub_u32 s17, s21, s17
  s_sub_u32 s18, s21, 80
  s_mul_i32 s19, s18, 52429
  s_lshr_b32 s19, s19, 21
  s_mul_i32 s20, s19, 40
  s_sub_u32 s20, s18, s20
  s_add_u32 s20, s20, 20
  s_cmp_lt_u32 s21, 80
  s_cselect_b32 s16, s16, s19
  s_cselect_b32 s17, s17, s20
  s_mov_b32 s8, s56
  s_and_b32 s9, s57, 0xffff
  s_mov_b32 s10, 4915200
  s_mov_b32 s11, 0x20000
  s_mov_b32 s12, s54
  s_and_b32 s13, s55, 0xffff
  s_mov_b32 s14, 1280
  s_mov_b32 s15, 0x20000
  v_mul_u32_u24 v3, 80, v2
  v_lshl_add_u32 v3, v1, 3, v3
  s_mul_i32 s18, s16, 320
  buffer_load_dwordx2 v[10:11], v3, s[12:15], s18 offen
  v_mul_u32_u24 v4, 307200, v2
  v_bfe_u32 v6, v0, 3, 1
  v_mul_u32_u24 v6, 7680, v6
  v_add_u32 v4, v4, v6
  v_and_b32 v6, 7, v0
  v_lshl_add_u32 v4, v6, 4, v4
  s_mul_i32 s18, s16, 1228800
  s_lshl_b32 s19, s17, 7
  s_add_u32 s18, s18, s19
  s_cmp_ge_u32 s21, 80
  s_cbranch_scc1 L_h0_slow
  buffer_load_dwordx4 v[40:43], v4, s[8:11], s18 offen nt
  s_add_u32 s18, s18, 15360
  buffer_load_dwordx4 v[44:47], v4, s[8:11], s18 offen nt
  s_add_u32 s18, s18, 15360
  buffer_load_dwordx4 v[48:51], v4, s[8:11], s18 offen nt
  s_add_u32 s18, s18, 15360
  buffer_load_dwordx4 v[52:55], v4, s[8:11], s18 offen nt
  s_add_u32 s18, s18, 15360
  buffer_load_dwordx4 v[56:59], v4, s[8:11], s18 offen nt
  s_add_u32 s18, s18, 15360
  buffer_load_dwordx4 v[60:63], v4, s[8:11], s18 offen nt
  s_add_u32 s18, s18, 15360
  buffer_load_dwordx4 v[64:67], v4, s[8:11], s18 offen nt
  s_add_u32 s18, s18, 15360
  buffer_load_dwordx4 v[68:71], v4, s[8:11], s18 offen nt
  s_add_u32 s18, s18, 15360
  buffer_load_dwordx4 v[72:75], v4, s[8:11], s18 offen nt
  s_add_u32 s18, s18, 15360
  buffer_load_dwordx4 v[76:79], v4, s[8:11], s18 offen nt
  s_add_u32 s18, s18, 15360
  buffer_load_dwordx4 v[80:83], v4, s[8:11], s18 offen nt
  s_add_u32 s18, s18, 15360
  buffer_load_dwordx4 v[84:87], v4, s[8:11], s18 offen nt
  s_add_u32 s18, s18, 15360
  buffer_load_dwordx4 v[88:91], v4, s[8:11], s18 offen nt
  s_add_u32 s18, s18, 15360
  buffer_load_dwordx4 v[92:95], v4, s[8:11], s18 offen nt
  s_add_u32 s18, s18, 15360
  buffer_load_dwordx4 v[96:99], v4, s[8:11], s18 offen nt
  s_add_u32 s18, s18, 15360
  buffer_load_dwordx4 v[100:103], v4, s[8:11], s18 offen nt
  s_add_u32 s18, s18, 15360
  buffer_load_dwordx4 v[104:107], v4, s[8:11], s18 offen nt
  s_add_u32 s18, s18, 15360
  buffer_load_dwordx4 v[108:111], v4, s[8:11], s18 offen nt
  s_add_u32 s18, s18, 15360
  buffer_load_dwordx4 v[112:115], v4, s[8:11], s18 offen nt
  s_add_u32 s18, s18, 15360
  buffer_load_dwordx4 v[116:119], v4, s[8:11], s18 offen nt
  s_waitcnt lgkmcnt(0)
  s_add_u32 s32, s32, 1
  v_mov_b32 v6, 0
  v_mov_b32 v7, 1
  s_mov_b64 exec, 1
  ds_add_u32 v6, v7 offset:4
  s_mov_b64 exec, -1
  s_branch L_h0_go
L_h0_slow:
  s_cmp_lg_u32 s23, 0
  s_cbranch_scc1 L_h0_nobar
  s_waitcnt lgkmcnt(0)
  s_add_u32 s32, s32, 1
  v_mov_b32 v6, 0
  v_mov_b32 v7, 1
  s_mov_b64 exec, 1
  ds_add_u32 v6, v7 offset:4
  s_mov_b64 exec, -1
L_h0_nobar:
  buffer_load_dwordx4 v[40:43], v4, s[8:11], s18 offen nt
  s_add_u32 s18, s18, 15360
  buffer_load_dwordx4 v[44:47], v4, s[8:11], s18 offen nt
  s_add_u32 s18, s18, 15360
  buffer_load_dwordx4 v[48:51], v4, s[8:11], s18 offen nt
  s_add_u32 s18, s18, 15360
  s_waitcnt vmcnt(5)
  s_cmp_eq_u32 s3, 3
  s_cbranch_scc1 Lpc_110
  s_waitcnt vmcnt(2)
Lpc_110:
  buffer_load_dwordx4 v[52:55], v4, s[8:11], s18 offen nt
  s_add_u32 s18, s18, 15360
  s_waitcnt vmcnt(5)
  s_cmp_eq_u32 s3, 3
  s_cbranch_scc1 Lpc_111
  s_waitcnt vmcnt(2)
Lpc_111:
  buffer_load_dwordx4 v[56:59], v4, s[8:11], s18 offen nt
  s_add_u32 s18, s18, 15360
  s_waitcnt vmcnt(5)
  s_cmp_eq_u32 s3, 3
  s_cbranch_scc1 Lpc_112
  s_waitcnt vmcnt(2)
Lpc_112:
  buffer_load_dwordx4 v[60:63], v4, s[8:11], s18 offen nt
  s_add_u32 s18, s18, 15360
  s_waitcnt vmcnt(5)
  s_cmp_eq_u32 s3, 3
  s_cbranch_scc1 Lpc_113
  s_waitcnt vmcnt(2)
Lpc_113:
  buffer_load_dwordx4 v[64:67], v4, s[8:11], s18 offen nt
  s_add_u32 s18, s18, 15360
  s_waitcnt vmcnt(5)
  s_cmp_eq_u32 s3, 3
  s_cbranch_scc1 Lpc_114
  s_waitcnt vmcnt(2)
Lpc_114:
  buffer_load_dwordx4 v[68:71], v4, s[8:11], s18 offen nt
  s_add_u32 s18, s18, 15360
  s_waitcnt vmcnt(5)
  s_cmp_eq_u32 s3, 3
  s_cbranch_scc1 Lpc_115
  s_waitcnt vmcnt(2)
Lpc_115:
  buffer_load_dwordx4 v[72:75], v4, s[8:11], s18 offen nt
  s_add_u32 s18, s18, 15360
  s_waitcnt vmcnt(5)
  s_cmp_eq_u32 s3, 3
  s_cbranch_scc1 Lpc_116
  s_waitcnt vmcnt(2)
Lpc_116:
  buffer_load_dwordx4 v[76:79], v4, s[8:11], s18 offen nt
  s_add_u32 s18, s18, 15360
  s_waitcnt vmcnt(5)
  s_cmp_eq_u32 s3, 3
  s_cbranch_scc1 Lpc_117
  s_waitcnt vmcnt(2)
Lpc_117:
  buffer_load_dwordx4 v[80:83], v4, s[8:11], s18 offen nt
  s_add_u32 s18, s18, 15360
  s_waitcnt vmcnt(5)
  s_cmp_eq_u32 s3, 3
  s_cbranch_scc1 Lpc_118
  s_waitcnt vmcnt(2)
Lpc_118:
  buffer_load_dwordx4 v[84:87], v4, s[8:11], s18 offen nt
  s_add_u32 s18, s18, 15360
  s_waitcnt vmcnt(5)
  s_cmp_eq_u32 s3, 3
  s_cbranch_scc1 Lpc_119
  s_waitcnt vmcnt(2)
Lpc_119:
  buffer_load_dwordx4 v[88:91], v4, s[8:11], s18 offen nt
  s_add_u32 s18, s18, 15360
  s_waitcnt vmcnt(5)
  s_cmp_eq_u32 s3, 3
  s_cbranch_scc1 Lpc_120
  s_waitcnt vmcnt(2)
Lpc_120:
  buffer_load_dwordx4 v[92:95], v4, s[8:11], s18 offen nt
  s_add_u32 s18, s18, 15360
  s_waitcnt vmcnt(5)
  s_cmp_eq_u32 s3, 3
  s_cbranch_scc1 Lpc_121
  s_waitcnt vmcnt(2)
Lpc_121:
  buffer_load_dwordx4 v[96:99], v4, s[8:11], s18 offen nt
  s_add_u32 s18, s18, 15360
  s_waitcnt vmcnt(5)
  s_cmp_eq_u32 s3, 3
  s_cbranch_scc1 Lpc_122
  s_waitcnt vmcnt(2)
Lpc_122:
  buffer_load_dwordx4 v[100:103], v4, s[8:11], s18 offen nt
  s_add_u32 s18, s18, 15360
  s_waitcnt vmcnt(5)
  s_cmp_eq_u32 s3, 3
  s_cbranch_scc1 Lpc_123
  s_waitcnt vmcnt(2)
Lpc_123:
  buffer_load_dwordx4 v[104:107], v4, s[8:11], s18 offen nt
  s_add_u32 s18, s18, 15360
  s_waitcnt vmcnt(5)
  s_cmp_eq_u32 s3, 3
  s_cbranch_scc1 Lpc_124
  s_waitcnt vmcnt(2)
Lpc_124:
  buffer_load_dwordx4 v[108:111], v4, s[8:11], s18 offen nt
  s_add_u32 s18, s18, 15360
  s_waitcnt vmcnt(5)
  s_cmp_eq_u32 s3, 3
  s_cbranch_scc1 Lpc_125
  s_waitcnt vmcnt(2)
Lpc_125:
  buffer_load_dwordx4 v[112:115], v4, s[8:11], s18 offen nt
  s_add_u32 s18, s18, 15360
  s_waitcnt vmcnt(5)
  s_cmp_eq_u32 s3, 3
  s_cbranch_scc1 Lpc_126
  s_waitcnt vmcnt(2)
Lpc_126:
  buffer_load_dwordx4 v[116:119], v4, s[8:11], s18 offen nt
L_h0_go:
  v_and_b32 v6, 1, v0
  v_lshlrev_b32 v6, 4, v6
  v_mov_b32 v7, 0xffff
  v_lshlrev_b32 v7, v6, v7
  v_bfe_u32 v6, v0, 1, 1
  v_cmp_eq_u32 vcc, 0, v6
  s_nop 1
  v_cndmask_b32 v24, 0, v7, vcc
  v_cmp_eq_u32 vcc, 1, v6
  s_nop 1
  v_cndmask_b32 v25, 0, v7, vcc
  s_waitcnt vmcnt(20)
  v_lshlrev_b32 v12, 16, v10
  v_and_b32 v13, 0xffff0000, v10
  v_lshlrev_b32 v14, 16, v11
  v_and_b32 v15, 0xffff0000, v11
  v_mul_f32 v6, 0xbfb8aa3b, v12
  v_exp_f32 v6, v6
  s_nop 0
  v_add_f32 v6, 1.0, v6
  v_rcp_f32 v6, v6
  s_nop 0
  v_mul_f32 v12, v12, v6
  v_mul_f32 v7, 0xbfb8aa3b, v13
  v_exp_f32 v7, v7
  s_nop 0
  v_add_f32 v7, 1.0, v7
  v_rcp_f32 v7, v7
  s_nop 0
  v_mul_f32 v13, v13, v7
  v_mul_f32 v8, 0xbfb8aa3b, v14
  v_exp_f32 v8, v8
  s_nop 0
  v_add_f32 v8, 1.0, v8
  v_rcp_f32 v8, v8
  s_nop 0
  v_mul_f32 v14, v14, v8
  v_mul_f32 v9, 0xbfb8aa3b, v15
  v_exp_f32 v9, v9
  s_nop 0
  v_add_f32 v9, 1.0, v9
  v_rcp_f32 v9, v9
  s_nop 0
  v_mul_f32 v15, v15, v9
  v_cvt_pk_bf16_f32 v12, v12, v12
  v_cvt_pk_bf16_f32 v13, v13, v13
  v_cvt_pk_bf16_f32 v14, v14, v14
  v_cvt_pk_bf16_f32 v15, v15, v15
  s_lshl_b32 s35, s3, 11
  v_lshl_add_u32 v6, v0, 4, s35
  v_lshl_add_u32 v7, v2, 8, s35
  v_lshl_add_u32 v7, v1, 3, v7
  v_add_u32 v7, 8192, v7
  s_waitcnt vmcnt(18)
  ds_write_b128 v6, v[40:43] offset:8192
  ds_write_b128 v6, v[44:47] offset:9216
  ds_read2_b64 v[40:43], v7 offset0:0 offset1:16
  ds_read2_b64 v[44:47], v7 offset0:128 offset1:144
  s_waitcnt lgkmcnt(4)
  s_waitcnt vmcnt(16)
  ds_write_b128 v6, v[48:51] offset:8192
  ds_write_b128 v6, v[52:55] offset:9216
  ds_read2_b64 v[48:51], v7 offset0:0 offset1:16
  ds_read2_b64 v[52:55], v7 offset0:128 offset1:144
  s_waitcnt lgkmcnt(4)
  s_waitcnt vmcnt(14)
  ds_write_b128 v6, v[56:59] offset:8192
  ds_write_b128 v6, v[60:63] offset:9216
  ds_read2_b64 v[56:59], v7 offset0:0 offset1:16
  ds_read2_b64 v[60:63], v7 offset0:128 offset1:144
  s_waitcnt lgkmcnt(4)
  s_waitcnt vmcnt(12)
  ds_write_b128 v6, v[64:67] offset:8192
  ds_write_b128 v6, v[68:71] offset:9216
  ds_read2_b64 v[64:67], v7 offset0:0 offset1:16
  ds_read2_b64 v[68:71], v7 offset0:128 offset1:144
  s_waitcnt lgkmcnt(4)
  s_waitcnt vmcnt(10)
  ds_write_b128 v6, v[72:75] offset:8192
  ds_write_b128 v6, v[76:79] offset:9216
  ds_read2_b64 v[72:75], v7 offset0:0 offset1:16
  ds_read2_b64 v[76:79], v7 offset0:128 offset1:144
  s_waitcnt lgkmcnt(4)
  s_waitcnt vmcnt(8)
  ds_write_b128 v6, v[80:83] offset:8192
  ds_write_b128 v6, v[84:87] offset:9216
  ds_read2_b64 v[80:83], v7 offset0:0 offset1:16
  ds_read2_b64 v[84:87], v7 offset0:128 offset1:144
  s_waitcnt lgkmcnt(4)
  s_waitcnt vmcnt(6)
  ds_write_b128 v6, v[88:91] offset:8192
  ds_write_b128 v6, v[92:95] offset:9216
  ds_read2_b64 v[88:91], v7 offset0:0 offset1:16
  ds_read2_b64 v[92:95], v7 offset0:128 offset1:144
  s_waitcnt lgkmcnt(4)
  s_waitcnt vmcnt(4)
  ds_write_b128 v6, v[96:99] offset:8192
  ds_write_b128 v6, v[100:103] offset:9216
  ds_read2_b64 v[96:99], v7 offset0:0 offset1:16
  ds_read2_b64 v[100:103], v7 offset0:128 offset1:144
  s_waitcnt lgkmcnt(4)
  s_waitcnt vmcnt(2)
  ds_write_b128 v6, v[104:107] offset:8192
  ds_write_b128 v6, v[108:111] offset:9216
  ds_read2_b64 v[104:107], v7 offset0:0 offset1:16
  ds_read2_b64 v[108:111], v7 offset0:128 offset1:144
  s_waitcnt lgkmcnt(4)
  s_waitcnt vmcnt(0)
  ds_write_b128 v6, v[112:115] offset:8192
  ds_write_b128 v6, v[116:119] offset:9216
  ds_read2_b64 v[112:115], v7 offset0:0 offset1:16
  ds_read2_b64 v[116:119], v7 offset0:128 offset1:144
  s_waitcnt lgkmcnt(4)
  s_waitcnt lgkmcnt(0)
  v_and_b32_dpp v28, v12, v24 row_newbcast:0 row_mask:0xf bank_mask:0xf
  v_and_b32_dpp v29, v12, v25 row_newbcast:0 row_mask:0xf bank_mask:0xf
  v_and_b32_dpp v30, v13, v24 row_newbcast:0 row_mask:0xf bank_mask:0xf
  v_and_b32_dpp v31, v13, v25 row_newbcast:0 row_mask:0xf bank_mask:0xf
  v_and_b32_dpp v32, v14, v24 row_newbcast:0 row_mask:0xf bank_mask:0xf
  v_and_b32_dpp v33, v14, v25 row_newbcast:0 row_mask:0xf bank_mask:0xf
  v_and_b32_dpp v34, v15, v24 row_newbcast:0 row_mask:0xf bank_mask:0xf
  v_and_b32_dpp v35, v15, v25 row_newbcast:0 row_mask:0xf bank_mask:0xf
  v_mfma_f32_16x16x32_bf16 v[16:19], v[28:31], v[40:43], 0
  v_and_b32_dpp v28, v12, v24 row_newbcast:1 row_mask:0xf bank_mask:0xf
  v_and_b32_dpp v29, v12, v25 row_newbcast:1 row_mask:0xf bank_mask:0xf
  v_and_b32_dpp v30, v13, v24 row_newbcast:1 row_mask:0xf bank_mask:0xf
  v_and_b32_dpp v31, v13, v25 row_newbcast:1 row_mask:0xf bank_mask:0xf
  v_mfma_f32_16x16x32_bf16 v[16:19], v[32:35], v[44:47], v[16:19]
  v_and_b32_dpp v32, v14, v24 row_newbcast:1 row_mask:0xf bank_mask:0xf
  v_and_b32_dpp v33, v14, v25 row_newbcast:1 row_mask:0xf bank_mask:0xf
  v_and_b32_dpp v34, v15, v24 row_newbcast:1 row_mask:0xf bank_mask:0xf
  v_and_b32_dpp v35, v15, v25 row_newbcast:1 row_mask:0xf bank_mask:0xf
  v_mfma_f32_16x16x32_bf16 v[16:19], v[28:31], v[48:51], v[16:19]
  v_and_b32_dpp v28, v12, v24 row_newbcast:2 row_mask:0xf bank_mask:0xf
  v_and_b32_dpp v29, v12, v25 row_newbcast:2 row_mask:0xf bank_mask:0xf
  v_and_b32_dpp v30, v13, v24 row_newbcast:2 row_mask:0xf bank_mask:0xf
  v_and_b32_dpp v31, v13, v25 row_newbcast:2 row_mask:0xf bank_mask:0xf
  v_mfma_f32_16x16x32_bf16 v[16:19], v[32:35], v[52:55], v[16:19]
  v_and_b32_dpp v32, v14, v24 row_newbcast:2 row_mask:0xf bank_mask:0xf
  v_and_b32_dpp v33, v14, v25 row_newbcast:2 row_mask:0xf bank_mask:0xf
  v_and_b32_dpp v34, v15, v24 row_newbcast:2 row_mask:0xf bank_mask:0xf
  v_and_b32_dpp v35, v15, v25 row_newbcast:2 row_mask:0xf bank_mask:0xf
  v_mfma_f32_16x16x32_bf16 v[16:19], v[28:31], v[56:59], v[16:19]
  v_and_b32_dpp v28, v12, v24 row_newbcast:3 row_mask:0xf bank_mask:0xf
  v_and_b32_dpp v29, v12, v25 row_newbcast:3 row_mask:0xf bank_mask:0xf
  v_and_b32_dpp v30, v13, v24 row_newbcast:3 row_mask:0xf bank_mask:0xf
  v_and_b32_dpp v31, v13, v25 row_newbcast:3 row_mask:0xf bank_mask:0xf
  v_mfma_f32_16x16x32_bf16 v[16:19], v[32:35], v[60:63], v[16:19]
  v_and_b32_dpp v32, v14, v24 row_newbcast:3 row_mask:0xf bank_mask:0xf
  v_and_b32_dpp v33, v14, v25 row_newbcast:3 row_mask:0xf bank_mask:0xf
  v_and_b32_dpp v34, v15, v24 row_newbcast:3 row_mask:0xf bank_mask:0xf
  v_and_b32_dpp v35, v15, v25 row_newbcast:3 row_mask:0xf bank_mask:0xf
  v_mfma_f32_16x16x32_bf16 v[16:19], v[28:31], v[64:67], v[16:19]
  v_and_b32_dpp v28, v12, v24 row_newbcast:4 row_mask:0xf bank_mask:0xf
  v_and_b32_dpp v29, v12, v25 row_newbcast:4 row_mask:0xf bank_mask:0xf
  v_and_b32_dpp v30, v13, v24 row_newbcast:4 row_mask:0xf bank_mask:0xf
  v_and_b32_dpp v31, v13, v25 row_newbcast:4 row_mask:0xf bank_mask:0xf
  v_mfma_f32_16x16x32_bf16 v[16:19], v[32:35], v[68:71], v[16:19]
  v_and_b32_dpp v32, v14, v24 row_newbcast:4 row_mask:0xf bank_mask:0xf
  v_and_b32_dpp v33, v14, v25 row_newbcast:4 row_mask:0xf bank_mask:0xf
  v_and_b32_dpp v34, v15, v24 row_newbcast:4 row_mask:0xf bank_mask:0xf
  v_and_b32_dpp v35, v15, v25 row_newbcast:4 row_mask:0xf bank_mask:0xf
  v_mfma_f32_16x16x32_bf16 v[16:19], v[28:31], v[72:75], v[16:19]
  v_and_b32_dpp v28, v12, v24 row_newbcast:5 row_mask:0xf bank_mask:0xf
  v_and_b32_dpp v29, v12, v25 row_newbcast:5 row_mask:0xf bank_mask:0xf
  v_and_b32_dpp v30, v13, v24 row_newbcast:5 row_mask:0xf bank_mask:0xf
  v_and_b32_dpp v31, v13, v25 row_newbcast:5 row_mask:0xf bank_mask:0xf
  v_mfma_f32_16x16x32_bf16 v[16:19], v[32:35], v[76:79], v[16:19]
  v_and_b32_dpp v32, v14, v24 row_newbcast:5 row_mask:0xf bank_mask:0xf
  v_and_b32_dpp v33, v14, v25 row_newbcast:5 row_mask:0xf bank_mask:0xf
  v_and_b32_dpp v34, v15, v24 row_newbcast:5 row_mask:0xf bank_mask:0xf
  v_and_b32_dpp v35, v15, v25 row_newbcast:5 row_mask:0xf bank_mask:0xf
  v_mfma_f32_16x16x32_bf16 v[16:19], v[28:31], v[80:83], v[16:19]
  v_and_b32_dpp v28, v12, v24 row_newbcast:6 row_mask:0xf bank_mask:0xf
  v_and_b32_dpp v29, v12, v25 row_newbcast:6 row_mask:0xf bank_mask:0xf
  v_and_b32_dpp v30, v13, v24 row_newbcast:6 row_mask:0xf bank_mask:0xf
  v_and_b32_dpp v31, v13, v25 row_newbcast:6 row_mask:0xf bank_mask:0xf
  v_mfma_f32_16x16x32_bf16 v[16:19], v[32:35], v[84:87], v[16:19]
  v_and_b32_dpp v32, v14, v24 row_newbcast:6 row_mask:0xf bank_mask:0xf
  v_and_b32_dpp v33, v14, v25 row_newbcast:6 row_mask:0xf bank_mask:0xf
  v_and_b32_dpp v34, v15, v24 row_newbcast:6 row_mask:0xf bank_mask:0xf
  v_and_b32_dpp v35, v15, v25 row_newbcast:6 row_mask:0xf bank_mask:0xf
  v_mfma_f32_16x16x32_bf16 v[16:19], v[28:31], v[88:91], v[16:19]
  v_and_b32_dpp v28, v12, v24 row_newbcast:7 row_mask:0xf bank_mask:0xf
  v_and_b32_dpp v29, v12, v25 row_newbcast:7 row_mask:0xf bank_mask:0xf
  v_and_b32_dpp v30, v13, v24 row_newbcast:7 row_mask:0xf bank_mask:0xf
  v_and_b32_dpp v31, v13, v25 row_newbcast:7 row_mask:0xf bank_mask:0xf
  v_mfma_f32_16x16x32_bf16 v[16:19], v[32:35], v[92:95], v[16:19]
  v_and_b32_dpp v32, v14, v24 row_newbcast:7 row_mask:0xf bank_mask:0xf
  v_and_b32_dpp v33, v14, v25 row_newbcast:7 row_mask:0xf bank_mask:0xf
  v_and_b32_dpp v34, v15, v24 row_newbcast:7 row_mask:0xf bank_mask:0xf
  v_and_b32_dpp v35, v15, v25 row_newbcast:7 row_mask:0xf bank_mask:0xf
  v_mfma_f32_16x16x32_bf16 v[16:19], v[28:31], v[96:99], v[16:19]
  v_and_b32_dpp v28, v12, v24 row_newbcast:8 row_mask:0xf bank_mask:0xf
  v_and_b32_dpp v29, v12, v25 row_newbcast:8 row_mask:0xf bank_mask:0xf
  v_and_b32_dpp v30, v13, v24 row_newbcast:8 row_mask:0xf bank_mask:0xf
  v_and_b32_dpp v31, v13, v25 row_newbcast:8 row_mask:0xf bank_mask:0xf
  v_mfma_f32_16x16x32_bf16 v[16:19], v[32:35], v[100:103], v[16:19]
  v_and_b32_dpp v32, v14, v24 row_newbcast:8 row_mask:0xf bank_mask:0xf
  v_and_b32_dpp v33, v14, v25 row_newbcast:8 row_mask:0xf bank_mask:0xf
  v_and_b32_dpp v34, v15, v24 row_newbcast:8 row_mask:0xf bank_mask:0xf
  v_and_b32_dpp v35, v15, v25 row_newbcast:8 row_mask:0xf bank_mask:0xf
  v_mfma_f32_16x16x32_bf16 v[16:19], v[28:31], v[104:107], v[16:19]
  v_and_b32_dpp v28, v12, v24 row_newbcast:9 row_mask:0xf bank_mask:0xf
  v_and_b32_dpp v29, v12, v25 row_newbcast:9 row_mask:0xf bank_mask:0xf
  v_and_b32_dpp v30, v13, v24 row_newbcast:9 row_mask:0xf bank_mask:0xf
  v_and_b32_dpp v31, v13, v25 row_newbcast:9 row_mask:0xf bank_mask:0xf
  v_mfma_f32_16x16x32_bf16 v[16:19], v[32:35], v[108:111], v[16:19]
  v_and_b32_dpp v32, v14, v24 row_newbcast:9 row_mask:0xf bank_mask:0xf
  v_and_b32_dpp v33, v14, v25 row_newbcast:9 row_mask:0xf bank_mask:0xf
  v_and_b32_dpp v34, v15, v24 row_newbcast:9 row_mask:0xf bank_mask:0xf
  v_and_b32_dpp v35, v15, v25 row_newbcast:9 row_mask:0xf bank_mask:0xf
  v_mfma_f32_16x16x32_bf16 v[16:19], v[28:31], v[112:115], v[16:19]
  s_nop 0
  v_mfma_f32_16x16x32_bf16 v[16:19], v[32:35], v[116:119], v[16:19]
  s_mul_i32 s18, s16, 30720
  s_lshl_b32 s19, s17, 9
  s_add_u32 s18, s18, s19
  s_add_u32 s20, s18, 0
  s_add_u32 s20, s62, s20
  s_addc_u32 s21, s63, 0
  v_lshlrev_b32 v3, 5, v1
  v_lshl_add_u32 v3, v2, 4, v3
  s_mov_b32 exec_hi, 0
  s_mov_b32 vcc_lo, 0xffff0000
  s_mov_b32 vcc_hi, 0
  v_cndmask_b32 v28, v16, v18, vcc
  v_cndmask_b32 v30, v17, v19, vcc
  v_mov_b32 v29, s32
  v_mov_b32 v31, s32
  global_store_dwordx4 v3, v[28:31], s[20:21] sc1
  s_mov_b64 exec, -1
  s_cmp_eq_u32 s3, 3
  s_cbranch_scc1 L_ctrl
  s_cmp_lg_u32 s33, 3
  s_cbranch_scc1 L_end
  s_cmp_eq_u32 s3, 0
  s_cbranch_scc1 L_final
  s_cmp_eq_u32 s3, 1
  s_cbranch_scc1 L_np
  s_endpgm
L_h0_skip:
  s_waitcnt lgkmcnt(0)
  s_add_u32 s32, s32, 1
  v_mov_b32 v6, 0
  v_mov_b32 v7, 1
  s_mov_b64 exec, 1
  ds_add_u32 v6, v7 offset:4
  s_mov_b64 exec, -1
  s_endpgm
L_h1:
  s_lshl_b32 s29, s100, 1
  s_add_u32 s29, s29, s3
  s_sub_u32 s29, s29, 1
  s_mov_b32 s8, s42
  s_and_b32 s9, s43, 0xffff
  s_mov_b32 s10, 5242880
  s_mov_b32 s11, 0x20000
  s_mov_b32 s12, s36
  s_and_b32 s13, s37, 0xffff
  s_mov_b32 s14, 1280
  s_mov_b32 s15, 0x20000
  v_lshlrev_b32 v3, 2, v0
  buffer_load_dword v10, v3, s[12:15], 0 offen offset:0
  buffer_load_dword v11, v3, s[12:15], 0 offen offset:256
  buffer_load_dword v12, v3, s[12:15], 0 offen offset:512
  buffer_load_dword v13, v3, s[12:15], 0 offen offset:768
  buffer_load_dword v14, v3, s[12:15], 0 offen offset:1024
  v_mul_u32_u24 v4, 40, v2
  v_lshl_add_u32 v4, v1, 2, v4
  s_mul_i32 s18, s29, 160
  buffer_load_dword v15, v4, s[12:15], s18 offen
  v_mul_u32_u24 v5, 163840, v2
  v_lshl_add_u32 v5, v1, 4, v5
  s_mul_i32 s18, s29, 655360
  s_lshl_b32 s19, s5, 8
  s_add_u32 s18, s18, s19
  s_waitcnt lgkmcnt(0)
  s_add_u32 s32, s32, 1
  v_mov_b32 v6, 0
  v_mov_b32 v7, 1
  s_mov_b64 exec, 1
  ds_add_u32 v6, v7 offset:4
  s_mov_b64 exec, -1
  v_and_b32 v6, 1, v0
  v_lshlrev_b32 v6, 4, v6
  v_mov_b32 v7, 0xffff
  v_lshlrev_b32 v7, v6, v7
  v_bfe_u32 v6, v0, 1, 2
  v_cmp_eq_u32 vcc, 0, v6
  s_nop 1
  v_cndmask_b32 v24, 0, v7, vcc
  v_cmp_eq_u32 vcc, 1, v6
  s_nop 1
  v_cndmask_b32 v25, 0, v7, vcc
  v_cmp_eq_u32 vcc, 2, v6
  s_nop 1
  v_cndmask_b32 v26, 0, v7, vcc
  v_cmp_eq_u32 vcc, 3, v6
  s_nop 1
  v_cndmask_b32 v27, 0, v7, vcc
  s_waitcnt vmcnt(0)
  v_lshlrev_b32 v120, 16, v10
  v_and_b32 v121, 0xffff0000, v10
  v_lshlrev_b32 v122, 16, v11
  v_and_b32 v123, 0xffff0000, v11
  v_lshlrev_b32 v124, 16, v12
  v_and_b32 v125, 0xffff0000, v12
  v_lshlrev_b32 v126, 16, v13
  v_and_b32 v127, 0xffff0000, v13
  v_lshlrev_b32 v128, 16, v14
  v_and_b32 v129, 0xffff0000, v14
  v_add_f32 v6, v120, v121
  v_add_f32 v6, v6, v122
  v_add_f32 v6, v6, v123
  v_add_f32 v6, v6, v124
  v_add_f32 v6, v6, v125
  v_add_f32 v6, v6, v126
  v_add_f32 v6, v6, v127
  v_add_f32 v6, v6, v128
  v_add_f32 v6, v6, v129
  s_nop 1
  v_add_f32_dpp v6, v6, v6 quad_perm:[1,0,3,2] row_mask:0xf bank_mask:0xf
  s_nop 1
  v_add_f32_dpp v6, v6, v6 quad_perm:[2,3,0,1] row_mask:0xf bank_mask:0xf
  s_nop 1
  v_add_f32_dpp v6, v6, v6 row_half_mirror row_mask:0xf bank_mask:0xf
  s_nop 1
  v_add_f32_dpp v6, v6, v6 row_mirror row_mask:0xf bank_mask:0xf
  s_nop 1
  v_add_f32_dpp v6, v6, v6 row_bcast:15 row_mask:0xa bank_mask:0xf
  s_nop 1
  v_add_f32_dpp v6, v6, v6 row_bcast:31 row_mask:0xc bank_mask:0xf
  s_nop 0
  v_readlane_b32 s22, v6, 63
  v_mov_b32 v8, 0x3acccccd
  s_nop 0
  v_mul_f32 v8, s22, v8
  v_sub_f32 v120, v120, v8
  v_sub_f32 v121, v121, v8
  v_sub_f32 v122, v122, v8
  v_sub_f32 v123, v123, v8
  v_sub_f32 v124, v124, v8
  v_sub_f32 v125, v125, v8
  v_sub_f32 v126, v126, v8
  v_sub_f32 v127, v127, v8
  v_sub_f32 v128, v128, v8
  v_sub_f32 v129, v129, v8
  v_mul_f32 v6, v120, v120
  v_fmac_f32 v6, v121, v121
  v_fmac_f32 v6, v122, v122
  v_fmac_f32 v6, v123, v123
  v_fmac_f32 v6, v124, v124
  v_fmac_f32 v6, v125, v125
  v_fmac_f32 v6, v126, v126
  v_fmac_f32 v6, v127, v127
  v_fmac_f32 v6, v128, v128
  v_fmac_f32 v6, v129, v129
  s_nop 1
  v_add_f32_dpp v6, v6, v6 quad_perm:[1,0,3,2] row_mask:0xf bank_mask:0xf
  s_nop 1
  v_add_f32_dpp v6, v6, v6 quad_perm:[2,3,0,1] row_mask:0xf bank_mask:0xf
  s_nop 1
  v_add_f32_dpp v6, v6, v6 row_half_mirror row_mask:0xf bank_mask:0xf
  s_nop 1
  v_add_f32_dpp v6, v6, v6 row_mirror row_mask:0xf bank_mask:0xf
  s_nop 1
  v_add_f32_dpp v6, v6, v6 row_bcast:15 row_mask:0xa bank_mask:0xf
  s_nop 1
  v_add_f32_dpp v6, v6, v6 row_bcast:31 row_mask:0xc bank_mask:0xf
  s_nop 0
  v_readlane_b32 s22, v6, 63
  v_mov_b32 v9, 0x3acccccd
  s_nop 0
  v_mul_f32 v9, s22, v9
  v_cvt_pk_bf16_f32 v6, v8, v9
  v_lshlrev_b32 v8, 16, v6
  v_and_b32 v9, 0xffff0000, v6
  v_add_f32 v9, 925353388, v9
  v_cvt_pk_bf16_f32 v9, v9, v9
  v_and_b32 v9, 0xffff0000, v9
  v_sqrt_f32 v9, v9
  s_nop 0
  v_cvt_pk_bf16_f32 v9, v9, v9
  v_and_b32 v9, 0xffff0000, v9
  v_rcp_f32 v9, v9
  v_lshlrev_b32 v12, 16, v15
  v_and_b32 v13, 0xffff0000, v15
  v_sub_f32 v12, v12, v8
  v_sub_f32 v13, v13, v8
  v_cvt_pk_bf16_f32 v6, v12, v13
  v_lshlrev_b32 v12, 16, v6
  v_and_b32 v13, 0xffff0000, v6
  v_mul_f32 v12, v12, v9
  v_mul_f32 v13, v13, v9
  v_cvt_pk_bf16_f32 v6, v12, v13
  v_lshlrev_b32 v12, 16, v6
  v_and_b32 v13, 0xffff0000, v6
  buffer_load_dwordx4 v[40:43], v5, s[8:11], s18 offen nt
  s_add_u32 s18, s18, 8192
  buffer_load_dwordx4 v[44:47], v5, s[8:11], s18 offen nt
  s_add_u32 s18, s18, 8192
  buffer_load_dwordx4 v[48:51], v5, s[8:11], s18 offen nt
  s_add_u32 s18, s18, 8192
  buffer_load_dwordx4 v[52:55], v5, s[8:11], s18 offen nt
  s_add_u32 s18, s18, 8192
  buffer_load_dwordx4 v[56:59], v5, s[8:11], s18 offen nt
  s_add_u32 s18, s18, 8192
  buffer_load_dwordx4 v[60:63], v5, s[8:11], s18 offen nt
  s_add_u32 s18, s18, 8192
  buffer_load_dwordx4 v[64:67], v5, s[8:11], s18 offen nt
  s_add_u32 s18, s18, 8192
  buffer_load_dwordx4 v[68:71], v5, s[8:11], s18 offen nt
  s_add_u32 s18, s18, 8192
  buffer_load_dwordx4 v[72:75], v5, s[8:11], s18 offen nt
  s_add_u32 s18, s18, 8192
  buffer_load_dwordx4 v[76:79], v5, s[8:11], s18 offen nt
  s_add_u32 s18, s18, 8192
  buffer_load_dwordx4 v[80:83], v5, s[8:11], s18 offen nt
  s_add_u32 s18, s18, 8192
  buffer_load_dwordx4 v[84:87], v5, s[8:11], s18 offen nt
  s_add_u32 s18, s18, 8192
  buffer_load_dwordx4 v[88:91], v5, s[8:11], s18 offen nt
  s_add_u32 s18, s18, 8192
  buffer_load_dwordx4 v[92:95], v5, s[8:11], s18 offen nt
  s_add_u32 s18, s18, 8192
  buffer_load_dwordx4 v[96:99], v5, s[8:11], s18 offen nt
  s_add_u32 s18, s18, 8192
  buffer_load_dwordx4 v[100:103], v5, s[8:11], s18 offen nt
  s_add_u32 s18, s18, 8192
  buffer_load_dwordx4 v[104:107], v5, s[8:11], s18 offen nt
  s_add_u32 s18, s18, 8192
  buffer_load_dwordx4 v[108:111], v5, s[8:11], s18 offen nt
  s_add_u32 s18, s18, 8192
  buffer_load_dwordx4 v[112:115], v5, s[8:11], s18 offen nt
  s_add_u32 s18, s18, 8192
  buffer_load_dwordx4 v[116:119], v5, s[8:11], s18 offen nt
  s_mul_i32 s18, s29, 640
  s_add_u32 s20, s18, 0
  s_add_u32 s20, s62, s20
  s_addc_u32 s21, s63, 0
  s_add_u32 s22, s20, 30720
  s_addc_u32 s23, s21, 0
  s_add_u32 s24, s22, 30720
  s_addc_u32 s25, s23, 0
  s_add_u32 s26, s24, 30720
  s_addc_u32 s27, s25, 0
  v_lshlrev_b32 v4, 2, v4
  v_add_u32 v5, 5120, v4
  s_mov_b32 s17, 96
  v_mov_b32 v8, 0
  s_mov_b32 s34, 0
Lw_127:
  ds_read_b32 v9, v8 offset:0
  s_waitcnt lgkmcnt(0)
  v_readfirstlane_b32 s35, v9
  s_nop 0
  s_cmp_ge_u32 s35, s17
  s_nop 1
  s_cbranch_scc1 Lwe_128
  s_sleep 4
  s_add_u32 s34, s34, 1
  s_cmp_lt_u32 s34, 800000
  s_cbranch_scc1 Lw_127
Lwe_128:
  s_mov_b32 exec_lo, 0x03ff03ff
  s_mov_b32 exec_hi, 0x03ff03ff
  s_mov_b32 s34, 0
Lp_129:
  global_load_dwordx4 v[120:123], v4, s[20:21] sc1
  global_load_dwordx4 v[124:127], v5, s[20:21] sc1
  global_load_dwordx4 v[128:131], v4, s[22:23] sc1
  global_load_dwordx4 v[132:135], v5, s[22:23] sc1
  global_load_dwordx4 v[136:139], v4, s[24:25] sc1
  global_load_dwordx4 v[140:143], v5, s[24:25] sc1
  global_load_dwordx4 v[144:147], v4, s[26:27] sc1
  global_load_dwordx4 v[148:151], v5, s[26:27] sc1
Lpf_131:
  s_waitcnt vmcnt(0)
  v_max_u32 v6, v121, v123
  v_max3_u32 v6, v6, v125, v127
  v_max3_u32 v6, v6, v129, v131
  v_max3_u32 v6, v6, v133, v135
  v_max3_u32 v6, v6, v137, v139
  v_max3_u32 v6, v6, v141, v143
  v_max3_u32 v6, v6, v145, v147
  v_max3_u32 v6, v6, v149, v151
  v_min_u32 v7, v121, v123
  v_min3_u32 v7, v7, v125, v127
  v_min3_u32 v7, v7, v129, v131
  v_min3_u32 v7, v7, v133, v135
  v_min3_u32 v7, v7, v137, v139
  v_min3_u32 v7, v7, v141, v143
  v_min3_u32 v7, v7, v145, v147
  v_min3_u32 v7, v7, v149, v151
  v_xor_b32 v6, s32, v6
  v_xor_b32 v7, s32, v7
  v_or_b32 v6, v6, v7
  v_cmp_ne_u32 vcc, 0, v6
  s_nop 0
  s_cmp_eq_u64 vcc, 0
  s_nop 1
  s_cbranch_scc1 Lpe_130
  s_sleep 8
  s_add_u32 s34, s34, 1
  s_cmp_lt_u32 s34, 200000
  s_cbranch_scc1 Lp_129
Lpe_130:
  s_mov_b64 exec, -1
  v_add_f32 v120, v120, v128
  v_add_f32 v136, v136, v144
  v_add_f32 v120, v120, v136
  v_add_f32 v122, v122, v130
  v_add_f32 v138, v138, v146
  v_add_f32 v122, v122, v138
  v_add_f32 v124, v124, v132
  v_add_f32 v140, v140, v148
  v_add_f32 v124, v124, v140
  v_add_f32 v126, v126, v134
  v_add_f32 v142, v142, v150
  v_add_f32 v126, v126, v142
  v_cvt_pk_bf16_f32 v6, v120, v122
  v_lshlrev_b32 v120, 16, v6
  v_and_b32 v122, 0xffff0000, v6
  v_cvt_pk_bf16_f32 v6, v124, v126
  v_lshlrev_b32 v124, 16, v6
  v_and_b32 v126, 0xffff0000, v6
  v_add_f32 v124, 1.0, v124
  v_add_f32 v126, 1.0, v126
  v_cvt_pk_bf16_f32 v6, v124, v126
  v_lshlrev_b32 v124, 16, v6
  v_and_b32 v126, 0xffff0000, v6
  v_mul_f32 v12, v12, v124
  v_mul_f32 v13, v13, v126
  v_cvt_pk_bf16_f32 v6, v12, v13
  v_lshlrev_b32 v12, 16, v6
  v_and_b32 v13, 0xffff0000, v6
  v_add_f32 v12, v12, v120
  v_add_f32 v13, v13, v122
  v_cvt_pk_bf16_f32 v12, v12, v12
  v_cvt_pk_bf16_f32 v13, v13, v13
  s_nop 0
  v_and_b32_dpp v28, v12, v24 row_newbcast:0 row_mask:0xf bank_mask:0xf
  v_and_b32_dpp v29, v12, v25 row_newbcast:0 row_mask:0xf bank_mask:0xf
  v_and_b32_dpp v30, v12, v26 row_newbcast:0 row_mask:0xf bank_mask:0xf
  v_and_b32_dpp v31, v12, v27 row_newbcast:0 row_mask:0xf bank_mask:0xf
  v_and_b32_dpp v32, v13, v24 row_newbcast:0 row_mask:0xf bank_mask:0xf
  v_and_b32_dpp v33, v13, v25 row_newbcast:0 row_mask:0xf bank_mask:0xf
  v_and_b32_dpp v34, v13, v26 row_newbcast:0 row_mask:0xf bank_mask:0xf
  v_and_b32_dpp v35, v13, v27 row_newbcast:0 row_mask:0xf bank_mask:0xf
  v_mfma_f32_16x16x32_bf16 v[16:19], v[28:31], v[40:43], 0
  v_and_b32_dpp v28, v12, v24 row_newbcast:1 row_mask:0xf bank_mask:0xf
  v_and_b32_dpp v29, v12, v25 row_newbcast:1 row_mask:0xf bank_mask:0xf
  v_and_b32_dpp v30, v12, v26 row_newbcast:1 row_mask:0xf bank_mask:0xf
  v_and_b32_dpp v31, v12, v27 row_newbcast:1 row_mask:0xf bank_mask:0xf
  v_mfma_f32_16x16x32_bf16 v[16:19], v[32:35], v[44:47], v[16:19]
  v_and_b32_dpp v32, v13, v24 row_newbcast:1 row_mask:0xf bank_mask:0xf
  v_and_b32_dpp v33, v13, v25 row_newbcast:1 row_mask:0xf bank_mask:0xf
  v_and_b32_dpp v34, v13, v26 row_newbcast:1 row_mask:0xf bank_mask:0xf
  v_and_b32_dpp v35, v13, v27 row_newbcast:1 row_mask:0xf bank_mask:0xf
  v_mfma_f32_16x16x32_bf16 v[16:19], v[28:31], v[48:51], v[16:19]
  v_and_b32_dpp v28, v12, v24 row_newbcast:2 row_mask:0xf bank_mask:0xf
  v_and_b32_dpp v29, v12, v25 row_newbcast:2 row_mask:0xf bank_mask:0xf
  v_and_b32_dpp v30, v12, v26 row_newbcast:2 row_mask:0xf bank_mask:0xf
  v_and_b32_dpp v31, v12, v27 row_newbcast:2 row_mask:0xf bank_mask:0xf
  v_mfma_f32_16x16x32_bf16 v[16:19], v[32:35], v[52:55], v[16:19]
  v_and_b32_dpp v32, v13, v24 row_newbcast:2 row_mask:0xf bank_mask:0xf
  v_and_b32_dpp v33, v13, v25 row_newbcast:2 row_mask:0xf bank_mask:0xf
  v_and_b32_dpp v34, v13, v26 row_newbcast:2 row_mask:0xf bank_mask:0xf
  v_and_b32_dpp v35, v13, v27 row_newbcast:2 row_mask:0xf bank_mask:0xf
  v_mfma_f32_16x16x32_bf16 v[16:19], v[28:31], v[56:59], v[16:19]
  v_and_b32_dpp v28, v12, v24 row_newbcast:3 row_mask:0xf bank_mask:0xf
  v_and_b32_dpp v29, v12, v25 row_newbcast:3 row_mask:0xf bank_mask:0xf
  v_and_b32_dpp v30, v12, v26 row_newbcast:3 row_mask:0xf bank_mask:0xf
  v_and_b32_dpp v31, v12, v27 row_newbcast:3 row_mask:0xf bank_mask:0xf
  v_mfma_f32_16x16x32_bf16 v[16:19], v[32:35], v[60:63], v[16:19]
  v_and_b32_dpp v32, v13, v24 row_newbcast:3 row_mask:0xf bank_mask:0xf
  v_and_b32_dpp v33, v13, v25 row_newbcast:3 row_mask:0xf bank_mask:0xf
  v_and_b32_dpp v34, v13, v26 row_newbcast:3 row_mask:0xf bank_mask:0xf
  v_and_b32_dpp v35, v13, v27 row_newbcast:3 row_mask:0xf bank_mask:0xf
  v_mfma_f32_16x16x32_bf16 v[16:19], v[28:31], v[64:67], v[16:19]
  v_and_b32_dpp v28, v12, v24 row_newbcast:4 row_mask:0xf bank_mask:0xf
  v_and_b32_dpp v29, v12, v25 row_newbcast:4 row_mask:0xf bank_mask:0xf
  v_and_b32_dpp v30, v12, v26 row_newbcast:4 row_mask:0xf bank_mask:0xf
  v_and_b32_dpp v31, v12, v27 row_newbcast:4 row_mask:0xf bank_mask:0xf
  v_mfma_f32_16x16x32_bf16 v[16:19], v[32:35], v[68:71], v[16:19]
  v_and_b32_dpp v32, v13, v24 row_newbcast:4 row_mask:0xf bank_mask:0xf
  v_and_b32_dpp v33, v13, v25 row_newbcast:4 row_mask:0xf bank_mask:0xf
  v_and_b32_dpp v34, v13, v26 row_newbcast:4 row_mask:0xf bank_mask:0xf
  v_and_b32_dpp v35, v13, v27 row_newbcast:4 row_mask:0xf bank_mask:0xf
  v_mfma_f32_16x16x32_bf16 v[16:19], v[28:31], v[72:75], v[16:19]
  v_and_b32_dpp v28, v12, v24 row_newbcast:5 row_mask:0xf bank_mask:0xf
  v_and_b32_dpp v29, v12, v25 row_newbcast:5 row_mask:0xf bank_mask:0xf
  v_and_b32_dpp v30, v12, v26 row_newbcast:5 row_mask:0xf bank_mask:0xf
  v_and_b32_dpp v31, v12, v27 row_newbcast:5 row_mask:0xf bank_mask:0xf
  v_mfma_f32_16x16x32_bf16 v[16:19], v[32:35], v[76:79], v[16:19]
  v_and_b32_dpp v32, v13, v24 row_newbcast:5 row_mask:0xf bank_mask:0xf
  v_and_b32_dpp v33, v13, v25 row_newbcast:5 row_mask:0xf bank_mask:0xf
  v_and_b32_dpp v34, v13, v26 row_newbcast:5 row_mask:0xf bank_mask:0xf
  v_and_b32_dpp v35, v13, v27 row_newbcast:5 row_mask:0xf bank_mask:0xf
  v_mfma_f32_16x16x32_bf16 v[16:19], v[28:31], v[80:83], v[16:19]
  v_and_b32_dpp v28, v12, v24 row_newbcast:6 row_mask:0xf bank_mask:0xf
  v_and_b32_dpp v29, v12, v25 row_newbcast:6 row_mask:0xf bank_mask:0xf
  v_and_b32_dpp v30, v12, v26 row_newbcast:6 row_mask:0xf bank_mask:0xf
  v_and_b32_dpp v31, v12, v27 row_newbcast:6 row_mask:0xf bank_mask:0xf
  v_mfma_f32_16x16x32_bf16 v[16:19], v[32:35], v[84:87], v[16:19]
  v_and_b32_dpp v32, v13, v24 row_newbcast:6 row_mask:0xf bank_mask:0xf
  v_and_b32_dpp v33, v13, v25 row_newbcast:6 row_mask:0xf bank_mask:0xf
  v_and_b32_dpp v34, v13, v26 row_newbcast:6 row_mask:0xf bank_mask:0xf
  v_and_b32_dpp v35, v13, v27 row_newbcast:6 row_mask:0xf bank_mask:0xf
  v_mfma_f32_16x16x32_bf16 v[16:19], v[28:31], v[88:91], v[16:19]
  v_and_b32_dpp v28, v12, v24 row_newbcast:7 row_mask:0xf bank_mask:0xf
  v_and_b32_dpp v29, v12, v25 row_newbcast:7 row_mask:0xf bank_mask:0xf
  v_and_b32_dpp v30, v12, v26 row_newbcast:7 row_mask:0xf bank_mask:0xf
  v_and_b32_dpp v31, v12, v27 row_newbcast:7 row_mask:0xf bank_mask:0xf
  v_mfma_f32_16x16x32_bf16 v[16:19], v[32:35], v[92:95], v[16:19]
  v_and_b32_dpp v32, v13, v24 row_newbcast:7 row_mask:0xf bank_mask:0xf
  v_and_b32_dpp v33, v13, v25 row_newbcast:7 row_mask:0xf bank_mask:0xf
  v_and_b32_dpp v34, v13, v26 row_newbcast:7 row_mask:0xf bank_mask:0xf
  v_and_b32_dpp v35, v13, v27 row_newbcast:7 row_mask:0xf bank_mask:0xf
  v_mfma_f32_16x16x32_bf16 v[16:19], v[28:31], v[96:99], v[16:19]
  v_and_b32_dpp v28, v12, v24 row_newbcast:8 row_mask:0xf bank_mask:0xf
  v_and_b32_dpp v29, v12, v25 row_newbcast:8 row_mask:0xf bank_mask:0xf
  v_and_b32_dpp v30, v12, v26 row_newbcast:8 row_mask:0xf bank_mask:0xf
  v_and_b32_dpp v31, v12, v27 row_newbcast:8 row_mask:0xf bank_mask:0xf
  v_mfma_f32_16x16x32_bf16 v[16:19], v[32:35], v[100:103], v[16:19]
  v_and_b32_dpp v32, v13, v24 row_newbcast:8 row_mask:0xf bank_mask:0xf
  v_and_b32_dpp v33, v13, v25 row_newbcast:8 row_mask:0xf bank_mask:0xf
  v_and_b32_dpp v34, v13, v26 row_newbcast:8 row_mask:0xf bank_mask:0xf
  v_and_b32_dpp v35, v13, v27 row_newbcast:8 row_mask:0xf bank_mask:0xf
  v_mfma_f32_16x16x32_bf16 v[16:19], v[28:31], v[104:107], v[16:19]
  v_and_b32_dpp v28, v12, v24 row_newbcast:9 row_mask:0xf bank_mask:0xf
  v_and_b32_dpp v29, v12, v25 row_newbcast:9 row_mask:0xf bank_mask:0xf
  v_and_b32_dpp v30, v12, v26 row_newbcast:9 row_mask:0xf bank_mask:0xf
  v_and_b32_dpp v31, v12, v27 row_newbcast:9 row_mask:0xf bank_mask:0xf
  v_mfma_f32_16x16x32_bf16 v[16:19], v[32:35], v[108:111], v[16:19]
  v_and_b32_dpp v32, v13, v24 row_newbcast:9 row_mask:0xf bank_mask:0xf
  v_and_b32_dpp v33, v13, v25 row_newbcast:9 row_mask:0xf bank_mask:0xf
  v_and_b32_dpp v34, v13, v26 row_newbcast:9 row_mask:0xf bank_mask:0xf
  v_and_b32_dpp v35, v13, v27 row_newbcast:9 row_mask:0xf bank_mask:0xf
  v_mfma_f32_16x16x32_bf16 v[16:19], v[28:31], v[112:115], v[16:19]
  s_nop 0
  v_mfma_f32_16x16x32_bf16 v[16:19], v[32:35], v[116:119], v[16:19]
  v_lshlrev_b32 v3, 4, v0
  s_cmp_eq_u32 s3, 1
  s_nop 4
  s_cbranch_scc1 L_qq1
  ds_write_b128 v3, v[16:19] offset:4608
  v_mov_b32 v6, 0
  v_mov_b32 v7, 1
  ds_write_b32 v6, v7 offset:36
  s_branch L_fz
L_qq1:
  v_mov_b32 v6, 0
  s_mov_b32 s34, 0
Lw_132:
  ds_read_b32 v7, v6 offset:36
  s_waitcnt lgkmcnt(0)
  v_readfirstlane_b32 s35, v7
  s_nop 0
  s_cmp_eq_u32 s35, 1
  s_nop 1
  s_cbranch_scc1 Lwe_133
  s_sleep 1
  s_add_u32 s34, s34, 1
  s_cmp_lt_u32 s34, 800000
  s_cbranch_scc1 Lw_132
Lwe_133:
  ds_read_b128 v[20:23], v3 offset:4608
  s_lshl_b32 s18, s5, 2
  s_add_u32 s18, s18, s100
  s_lshl_b32 s18, s18, 10
  s_add_u32 s20, s18, 131072
  s_add_u32 s20, s62, s20
  s_addc_u32 s21, s63, 0
  v_and_b32 v3, 1, v2
  v_lshlrev_b32 v3, 5, v3
  v_lshl_add_u32 v3, v1, 6, v3
  v_lshrrev_b32 v6, 1, v2
  v_lshl_add_u32 v3, v6, 4, v3
  s_waitcnt lgkmcnt(0)
  v_pk_add_f32 v[16:17], v[16:17], v[20:21]
  v_pk_add_f32 v[18:19], v[18:19], v[22:23]
  s_mov_b32 vcc_lo, 0
  s_mov_b32 vcc_hi, -1
  v_cndmask_b32 v28, v16, v18, vcc
  v_cndmask_b32 v30, v17, v19, vcc
  v_mov_b32 v29, s32
  v_mov_b32 v31, s32
  global_store_dwordx4 v3, v[28:31], s[20:21] sc1
  s_mov_b32 s17, 224
  s_cmp_eq_u32 s33, 2
  s_cselect_b32 s17, 240, s17
  s_cmp_eq_u32 s33, 3
  s_cselect_b32 s17, 256, s17
  v_mov_b32 v8, 0
  s_mov_b32 s34, 0
Lw_134:
  ds_read_b32 v9, v8 offset:0
  s_waitcnt lgkmcnt(0)
  v_readfirstlane_b32 s35, v9
  s_nop 0
  s_cmp_ge_u32 s35, s17
  s_nop 1
  s_cbranch_scc1 Lwe_135
  s_sleep 4
  s_add_u32 s34, s34, 1
  s_cmp_lt_u32 s34, 800000
  s_cbranch_scc1 Lw_134
Lwe_135:
  s_lshl_b32 s18, s5, 12
  s_add_u32 s20, s18, 131072
  s_add_u32 s20, s62, s20
  s_addc_u32 s21, s63, 0
  v_lshlrev_b32 v7, 4, v0
  s_mov_b32 s34, 0
Lp_136:
  global_load_dwordx4 v[8:11], v7, s[20:21] offset:0 sc1
  global_load_dwordx4 v[12:15], v7, s[20:21] offset:1024 sc1
  global_load_dwordx4 v[16:19], v7, s[20:21] offset:2048 sc1
  global_load_dwordx4 v[20:23], v7, s[20:21] offset:3072 sc1
Lpf_138:
  s_waitcnt vmcnt(0)
  v_max_u32 v24, v9, v11
  v_max3_u32 v24, v24, v13, v15
  v_max3_u32 v24, v24, v17, v19
  v_max3_u32 v24, v24, v21, v23
  v_min_u32 v25, v9, v11
  v_min3_u32 v25, v25, v13, v15
  v_min3_u32 v25, v25, v17, v19
  v_min3_u32 v25, v25, v21, v23
  v_xor_b32 v24, s32, v24
  v_xor_b32 v25, s32, v25
  v_or_b32 v24, v24, v25
  v_cmp_ne_u32 vcc, 0, v24
  s_nop 0
  s_cmp_eq_u64 vcc, 0
  s_nop 1
  s_cbranch_scc1 Lpe_137
  s_sleep 8
  s_add_u32 s34, s34, 1
  s_cmp_lt_u32 s34, 200000
  s_cbranch_scc1 Lp_136
Lpe_137:
  v_add_f32 v8, v8, v12
  v_add_f32 v10, v10, v14
  v_add_f32 v16, v16, v20
  v_add_f32 v18, v18, v22
  v_add_f32 v8, v8, v16
  v_add_f32 v10, v10, v18
  v_cvt_pk_bf16_f32 v6, v8, v10
  v_lshlrev_b32 v7, 2, v0
  ds_write_b32 v7, v6 offset:128
  v_mov_b32 v6, 0
  s_mov_b32 s34, 0
Lw_139:
  ds_read_b32 v7, v6 offset:4
  s_waitcnt lgkmcnt(0)
  v_readfirstlane_b32 s35, v7
  s_nop 0
  s_cmp_eq_u32 s35, 4
  s_nop 1
  s_cbranch_scc1 Lwe_140
  s_sleep 1
  s_add_u32 s34, s34, 1
  s_cmp_lt_u32 s34, 800000
  s_cbranch_scc1 Lw_139
Lwe_140:
  v_mov_b32 v7, s32
  ds_write_b32 v6, v7 offset:24
  v_mov_b32 v6, 0
  v_mov_b32 v7, 1
  ds_write_b32 v6, v7 offset:8
  s_endpgm
L_fz:
  s_cmp_lt_u32 s7, 118
  s_cbranch_scc1 L_end
  s_sub_u32 s29, s7, 118
  s_lshl_b32 s18, s29, 9
  s_add_u32 s20, s18, 10240
  s_add_u32 s20, s62, s20
  s_addc_u32 s21, s63, 0
  s_add_u32 s22, s20, 30720
  s_addc_u32 s23, s21, 0
  s_add_u32 s24, s22, 30720
  s_addc_u32 s25, s23, 0
  s_add_u32 s26, s24, 30720
  s_addc_u32 s27, s25, 0
  s_mov_b32 s17, 240
  v_mov_b32 v6, 0
  s_mov_b32 s34, 0
Lw_141:
  ds_read_b32 v7, v6 offset:0
  s_waitcnt lgkmcnt(0)
  v_readfirstlane_b32 s35, v7
  s_nop 0
  s_cmp_ge_u32 s35, s17
  s_nop 1
  s_cbranch_scc1 Lwe_142
  s_sleep 4
  s_add_u32 s34, s34, 1
  s_cmp_lt_u32 s34, 800000
  s_cbranch_scc1 Lw_141
Lwe_142:
  v_lshlrev_b32 v3, 3, v0
  v_add_u32 v4, 5120, v3
  v_add_u32 v5, 10240, v3
  v_add_u32 v8, 15360, v3
  s_mov_b32 s34, 0
Lp_143:
  global_load_dwordx2 v[40:41], v3, s[20:21] sc1
  global_load_dwordx2 v[42:43], v4, s[20:21] sc1
  global_load_dwordx2 v[44:45], v5, s[20:21] sc1
  global_load_dwordx2 v[46:47], v8, s[20:21] sc1
  global_load_dwordx2 v[48:49], v3, s[22:23] sc1
  global_load_dwordx2 v[50:51], v4, s[22:23] sc1
  global_load_dwordx2 v[52:53], v5, s[22:23] sc1
  global_load_dwordx2 v[54:55], v8, s[22:23] sc1
  global_load_dwordx2 v[56:57], v3, s[24:25] sc1
  global_load_dwordx2 v[58:59], v4, s[24:25] sc1
  global_load_dwordx2 v[60:61], v5, s[24:25] sc1
  global_load_dwordx2 v[62:63], v8, s[24:25] sc1
  global_load_dwordx2 v[64:65], v3, s[26:27] sc1
  global_load_dwordx2 v[66:67], v4, s[26:27] sc1
  global_load_dwordx2 v[68:69], v5, s[26:27] sc1
  global_load_dwordx2 v[70:71], v8, s[26:27] sc1
Lpf_145:
  s_waitcnt vmcnt(0)
  v_max_u32 v6, v41, v43
  v_max3_u32 v6, v6, v45, v47
  v_max3_u32 v6, v6, v49, v51
  v_max3_u32 v6, v6, v53, v55
  v_max3_u32 v6, v6, v57, v59
  v_max3_u32 v6, v6, v61, v63
  v_max3_u32 v6, v6, v65, v67
  v_max3_u32 v6, v6, v69, v71
  v_min_u32 v7, v41, v43
  v_min3_u32 v7, v7, v45, v47
  v_min3_u32 v7, v7, v49, v51
  v_min3_u32 v7, v7, v53, v55
  v_min3_u32 v7, v7, v57, v59
  v_min3_u32 v7, v7, v61, v63
  v_min3_u32 v7, v7, v65, v67
  v_min3_u32 v7, v7, v69, v71
  v_xor_b32 v6, s32, v6
  v_xor_b32 v7, s32, v7
  v_or_b32 v6, v6, v7
  v_cmp_ne_u32 vcc, 0, v6
  s_nop 0
  s_cmp_eq_u64 vcc, 0
  s_nop 1
  s_cbranch_scc1 Lpe_144
  s_sleep 8
  s_add_u32 s34, s34, 1
  s_cmp_lt_u32 s34, 200000
  s_cbranch_scc1 Lp_143
Lpe_144:
  v_add_f32 v40, v40, v48
  v_add_f32 v56, v56, v64
  v_add_f32 v40, v40, v56
  v_add_f32 v42, v42, v50
  v_add_f32 v58, v58, v66
  v_add_f32 v42, v42, v58
  v_add_f32 v44, v44, v52
  v_add_f32 v60, v60, v68
  v_add_f32 v44, v44, v60
  v_add_f32 v46, v46, v54
  v_add_f32 v62, v62, v70
  v_add_f32 v46, v46, v62
  v_cvt_pk_bf16_f32 v44, v44, v44
  v_and_b32 v44, 0xffff0000, v44
  v_add_f32 v44, 1.0, v44
  v_cvt_pk_bf16_f32 v12, v40, v42
  v_cvt_pk_bf16_f32 v14, v44, v46
  v_mov_b32 v13, s32
  v_mov_b32 v15, s32
  v_and_b32 v3, 3, v0
  v_mul_u32_u24 v3, 2560, v3
  v_lshrrev_b32 v4, 2, v0
  v_lshl_add_u32 v3, v4, 4, v3
  s_lshl_b32 s18, s29, 8
  s_add_u32 s20, s18, 331776
  s_add_u32 s20, s62, s20
  s_addc_u32 s21, s63, 0
  global_store_dwordx4 v3, v[12:15], s[20:21] sc1
  s_endpgm
L_h3:
  s_memrealtime s[76:77]
  s_lshl_b32 s18, s5, 21
  s_mul_i32 s19, s6, 180224
  s_add_u32 s18, s18, s19
  s_add_u32 s20, s40, s18
  s_addc_u32 s21, s41, 0
  s_load_dword s64, s[20:21], 0
  s_load_dword s65, s[20:21], 65536
  s_load_dword s66, s[20:21], 131072
  s_mov_b32 s18, 0
  s_cmp_eq_u32 s33, 1
  s_cselect_b32 s18, 0, s18
  s_cmp_eq_u32 s33, 2
  s_cselect_b32 s18, 0, s18
  s_cmp_eq_u32 s33, 3
  s_cselect_b32 s18, 0, s18
  s_cmp_eq_u32 s33, 4
  s_cselect_b32 s18, 0, s18
  v_mov_b32 v8, 0
  v_mov_b32 v9, s18
  s_mov_b64 exec, 1
  ds_add_u32 v8, v9 offset:0
  s_mov_b64 exec, -1
  s_waitcnt lgkmcnt(0)
  s_add_u32 s32, s32, 1
  v_mov_b32 v6, 0
  v_mov_b32 v7, 1
  s_mov_b64 exec, 1
  ds_add_u32 v6, v7 offset:4
  s_mov_b64 exec, -1
  s_cmp_lg_u32 s33, 0
  s_cbranch_scc1 L_tailw
  s_cmp_ge_u32 s7, 19
  s_cbranch_scc1 L_ctrl
  s_add_u32 s21, s7, 221
  s_mov_b32 s23, 1
  s_branch L_h0_unit
L_h2:
  s_waitcnt lgkmcnt(0)
  s_add_u32 s32, s32, 1
  v_mov_b32 v6, 0
  v_mov_b32 v7, 1
  s_mov_b64 exec, 1
  ds_add_u32 v6, v7 offset:4
  s_mov_b64 exec, -1
L_tailw:
  s_cmp_eq_u32 s33, 2
  s_cbranch_scc1 L_tw_g
  s_cmp_eq_u32 s33, 3
  s_cbranch_scc1 L_tw_none
  s_mul_i32 s28, s7, 52429
  s_lshr_b32 s28, s28, 18
  s_mul_i32 s29, s28, 5
  s_sub_u32 s29, s7, s29
  s_mov_b32 s8, s44
  s_and_b32 s9, s45, 0xffff
  s_mov_b32 s10, 5242880
  s_mov_b32 s11, 0x20000
  v_mul_u32_u24 v3, 1280, v2
  v_lshl_add_u32 v3, v1, 4, v3
  s_mul_i32 s18, s28, 655360
  s_lshl_b32 s19, s29, 8
  s_add_u32 s18, s18, s19
  s_mul_i32 s19, s3, 40960
  s_add_u32 s18, s18, s19
  buffer_load_dwordx4 v[40:43], v3, s[8:11], s18 offen nt
  s_add_u32 s18, s18, 5120
  buffer_load_dwordx4 v[44:47], v3, s[8:11], s18 offen nt
  s_add_u32 s18, s18, 5120
  buffer_load_dwordx4 v[48:51], v3, s[8:11], s18 offen nt
  s_add_u32 s18, s18, 5120
  buffer_load_dwordx4 v[52:55], v3, s[8:11], s18 offen nt
  s_waitcnt vmcnt(3)
  s_add_u32 s18, s18, 5120
  buffer_load_dwordx4 v[56:59], v3, s[8:11], s18 offen nt
  s_waitcnt vmcnt(3)
  s_add_u32 s18, s18, 5120
  buffer_load_dwordx4 v[60:63], v3, s[8:11], s18 offen nt
  s_waitcnt vmcnt(3)
  s_add_u32 s18, s18, 5120
  buffer_load_dwordx4 v[64:67], v3, s[8:11], s18 offen nt
  s_waitcnt vmcnt(3)
  s_add_u32 s18, s18, 5120
  buffer_load_dwordx4 v[68:71], v3, s[8:11], s18 offen nt
  s_waitcnt vmcnt(3)
  s_add_u32 s18, s18, 128000
  buffer_load_dwordx4 v[72:75], v3, s[8:11], s18 offen nt
  s_waitcnt vmcnt(3)
  s_add_u32 s18, s18, 5120
  buffer_load_dwordx4 v[76:79], v3, s[8:11], s18 offen nt
  s_waitcnt vmcnt(3)
  s_add_u32 s18, s18, 5120
  buffer_load_dwordx4 v[80:83], v3, s[8:11], s18 offen nt
  s_waitcnt vmcnt(3)
  s_add_u32 s18, s18, 5120
  buffer_load_dwordx4 v[84:87], v3, s[8:11], s18 offen nt
  s_waitcnt vmcnt(3)
  s_add_u32 s18, s18, 5120
  buffer_load_dwordx4 v[88:91], v3, s[8:11], s18 offen nt
  s_waitcnt vmcnt(3)
  s_add_u32 s18, s18, 5120
  buffer_load_dwordx4 v[92:95], v3, s[8:11], s18 offen nt
  s_waitcnt vmcnt(3)
  s_add_u32 s18, s18, 5120
  buffer_load_dwordx4 v[96:99], v3, s[8:11], s18 offen nt
  s_waitcnt vmcnt(3)
  s_add_u32 s18, s18, 5120
  buffer_load_dwordx4 v[100:103], v3, s[8:11], s18 offen nt
  s_waitcnt vmcnt(3)
  s_add_u32 s18, s18, 128000
  buffer_load_dwordx4 v[104:107], v3, s[8:11], s18 offen nt
  s_waitcnt vmcnt(3)
  s_add_u32 s18, s18, 5120
  buffer_load_dwordx4 v[108:111], v3, s[8:11], s18 offen nt
  s_waitcnt vmcnt(3)
  s_add_u32 s18, s18, 5120
  buffer_load_dwordx4 v[112:115], v3, s[8:11], s18 offen nt
  s_waitcnt vmcnt(3)
  s_add_u32 s18, s18, 5120
  buffer_load_dwordx4 v[116:119], v3, s[8:11], s18 offen nt
  s_waitcnt vmcnt(3)
  s_add_u32 s18, s18, 5120
  buffer_load_dwordx4 v[120:123], v3, s[8:11], s18 offen nt
  s_waitcnt vmcnt(3)
  s_add_u32 s18, s18, 5120
  buffer_load_dwordx4 v[124:127], v3, s[8:11], s18 offen nt
  s_cmp_lg_u32 s3, 1
  s_cbranch_scc1 Lmid_146
  s_mov_b32 s31, s18
  s_mov_b32 s17, 224
  s_cmp_eq_u32 s33, 2
  s_cselect_b32 s17, 240, s17
  s_cmp_eq_u32 s33, 3
  s_cselect_b32 s17, 256, s17
  v_mov_b32 v8, 0
  s_mov_b32 s34, 0
Lw_147:
  ds_read_b32 v9, v8 offset:0
  s_waitcnt lgkmcnt(0)
  v_readfirstlane_b32 s35, v9
  s_nop 0
  s_cmp_ge_u32 s35, s17
  s_nop 1
  s_cbranch_scc1 Lwe_148
  s_sleep 4
  s_add_u32 s34, s34, 1
  s_cmp_lt_u32 s34, 800000
  s_cbranch_scc1 Lw_147
Lwe_148:
  s_lshl_b32 s18, s5, 12
  s_add_u32 s20, s18, 131072
  s_add_u32 s20, s62, s20
  s_addc_u32 s21, s63, 0
  v_lshlrev_b32 v7, 4, v0
  s_mov_b32 s34, 0
Lp_149:
  global_load_dwordx4 v[8:11], v7, s[20:21] offset:0 sc1
  global_load_dwordx4 v[12:15], v7, s[20:21] offset:1024 sc1
  global_load_dwordx4 v[16:19], v7, s[20:21] offset:2048 sc1
  global_load_dwordx4 v[20:23], v7, s[20:21] offset:3072 sc1
Lpf_151:
  s_waitcnt vmcnt(0)
  v_max_u32 v24, v9, v11
  v_max3_u32 v24, v24, v13, v15
  v_max3_u32 v24, v24, v17, v19
  v_max3_u32 v24, v24, v21, v23
  v_min_u32 v25, v9, v11
  v_min3_u32 v25, v25, v13, v15
  v_min3_u32 v25, v25, v17, v19
  v_min3_u32 v25, v25, v21, v23
  v_xor_b32 v24, s32, v24
  v_xor_b32 v25, s32, v25
  v_or_b32 v24, v24, v25
  v_cmp_ne_u32 vcc, 0, v24
  s_nop 0
  s_cmp_eq_u64 vcc, 0
  s_nop 1
  s_cbranch_scc1 Lpe_150
  s_sleep 8
  s_add_u32 s34, s34, 1
  s_cmp_lt_u32 s34, 200000
  s_cbranch_scc1 Lp_149
Lpe_150:
  v_add_f32 v8, v8, v12
  v_add_f32 v10, v10, v14
  v_add_f32 v16, v16, v20
  v_add_f32 v18, v18, v22
  v_add_f32 v8, v8, v16
  v_add_f32 v10, v10, v18
  v_cvt_pk_bf16_f32 v6, v8, v10
  v_lshlrev_b32 v7, 2, v0
  ds_write_b32 v7, v6 offset:128
  v_mov_b32 v6, 0
  s_mov_b32 s34, 0
Lw_152:
  ds_read_b32 v7, v6 offset:4
  s_waitcnt lgkmcnt(0)
  v_readfirstlane_b32 s35, v7
  s_nop 0
  s_cmp_eq_u32 s35, 4
  s_nop 1
  s_cbranch_scc1 Lwe_153
  s_sleep 1
  s_add_u32 s34, s34, 1
  s_cmp_lt_u32 s34, 800000
  s_cbranch_scc1 Lw_152
Lwe_153:
  v_mov_b32 v7, s32
  ds_write_b32 v6, v7 offset:24
  v_mov_b32 v6, 0
  v_mov_b32 v7, 1
  ds_write_b32 v6, v7 offset:8
  s_mov_b32 s18, s31
Lmid_146:
  s_waitcnt vmcnt(3)
  s_add_u32 s18, s18, 5120
  buffer_load_dwordx4 v[128:131], v3, s[8:11], s18 offen nt
  s_waitcnt vmcnt(3)
  s_add_u32 s18, s18, 5120
  buffer_load_dwordx4 v[132:135], v3, s[8:11], s18 offen nt
  s_cmp_eq_u32 s3, 3
  s_cbranch_scc1 L_tw_done
  s_waitcnt vmcnt(3)
  s_add_u32 s18, s18, 128000
  buffer_load_dwordx4 v[136:139], v3, s[8:11], s18 offen nt
  s_waitcnt vmcnt(3)
  s_add_u32 s18, s18, 5120
  buffer_load_dwordx4 v[140:143], v3, s[8:11], s18 offen nt
  s_waitcnt vmcnt(3)
  s_add_u32 s18, s18, 5120
  buffer_load_dwordx4 v[144:147], v3, s[8:11], s18 offen nt
  s_waitcnt vmcnt(3)
  s_add_u32 s18, s18, 5120
  buffer_load_dwordx4 v[148:151], v3, s[8:11], s18 offen nt
  s_waitcnt vmcnt(3)
  s_add_u32 s18, s18, 5120
  buffer_load_dwordx4 v[152:155], v3, s[8:11], s18 offen nt
  s_waitcnt vmcnt(3)
  s_add_u32 s18, s18, 5120
  buffer_load_dwordx4 v[156:159], v3, s[8:11], s18 offen nt
  s_waitcnt vmcnt(3)
  s_add_u32 s18, s18, 5120
  buffer_load_dwordx4 v[160:163], v3, s[8:11], s18 offen nt
  s_waitcnt vmcnt(3)
  s_add_u32 s18, s18, 5120
  buffer_load_dwordx4 v[164:167], v3, s[8:11], s18 offen nt
  s_branch L_tw_done
L_tw_g:
  s_sub_u32 s28, s7, 40
  s_min_u32 s29, s3, 2
  s_lshl_b32 s29, s29, 12
  s_lshl_b32 s19, s3, 13
  s_add_u32 s29, s29, s19
  s_add_u32 s29, s29, 16384
  v_mov_b32 v16, s48
  v_mov_b32 v17, s49
  v_mov_b32 v18, s50
  v_mov_b32 v19, s51
  v_and_b32 v22, 4, v0
  v_cmp_eq_u32 vcc, 0, v22
  s_nop 1
  v_cndmask_b32 v16, v18, v16, vcc
  v_cndmask_b32 v17, v19, v17, vcc
  v_mul_u32_u24 v22, 138240, v2
  v_bfe_u32 v18, v0, 3, 1
  v_mul_u32_u24 v18, 3456, v18
  v_add_u32 v22, v22, v18
  v_and_b32 v18, 3, v0
  v_lshl_add_u32 v22, v18, 4, v22
  s_mul_i32 s18, s3, 552960
  s_lshl_b32 s19, s28, 6
  s_add_u32 s18, s18, s19
  s_add_u32 s18, s18, 0
  v_add_u32 v22, s18, v22
  v_add_co_u32 v16, vcc, v16, v22
  s_nop 1
  v_addc_co_u32 v17, vcc, 0, v17, vcc
  global_load_dwordx4 v[40:43], v[16:17], off nt
  v_add_co_u32 v16, vcc, 6912, v16
  s_nop 1
  v_addc_co_u32 v17, vcc, 0, v17, vcc
  global_load_dwordx4 v[44:47], v[16:17], off nt
  v_add_co_u32 v16, vcc, 6912, v16
  s_nop 1
  v_addc_co_u32 v17, vcc, 0, v17, vcc
  s_waitcnt vmcnt(1)
  global_load_dwordx4 v[48:51], v[16:17], off nt
  v_add_co_u32 v16, vcc, 6912, v16
  s_nop 1
  v_addc_co_u32 v17, vcc, 0, v17, vcc
  s_waitcnt vmcnt(1)
  global_load_dwordx4 v[52:55], v[16:17], off nt
  v_add_co_u32 v16, vcc, 6912, v16
  s_nop 1
  v_addc_co_u32 v17, vcc, 0, v17, vcc
  s_waitcnt vmcnt(1)
  global_load_dwordx4 v[56:59], v[16:17], off nt
  v_add_co_u32 v16, vcc, 6912, v16
  s_nop 1
  v_addc_co_u32 v17, vcc, 0, v17, vcc
  s_waitcnt vmcnt(1)
  global_load_dwordx4 v[60:63], v[16:17], off nt
  v_add_co_u32 v16, vcc, 6912, v16
  s_nop 1
  v_addc_co_u32 v17, vcc, 0, v17, vcc
  s_waitcnt vmcnt(1)
  global_load_dwordx4 v[64:67], v[16:17], off nt
  v_add_co_u32 v16, vcc, 6912, v16
  s_nop 1
  v_addc_co_u32 v17, vcc, 0, v17, vcc
  s_waitcnt vmcnt(1)
  global_load_dwordx4 v[68:71], v[16:17], off nt
  v_add_co_u32 v16, vcc, 6912, v16
  s_nop 1
  v_addc_co_u32 v17, vcc, 0, v17, vcc
  s_waitcnt vmcnt(1)
  global_load_dwordx4 v[72:75], v[16:17], off nt
  v_add_co_u32 v16, vcc, 6912, v16
  s_nop 1
  v_addc_co_u32 v17, vcc, 0, v17, vcc
  s_waitcnt vmcnt(1)
  global_load_dwordx4 v[76:79], v[16:17], off nt
  v_add_co_u32 v16, vcc, 6912, v16
  s_nop 1
  v_addc_co_u32 v17, vcc, 0, v17, vcc
  s_waitcnt vmcnt(1)
  global_load_dwordx4 v[80:83], v[16:17], off nt
  v_add_co_u32 v16, vcc, 6912, v16
  s_nop 1
  v_addc_co_u32 v17, vcc, 0, v17, vcc
  s_waitcnt vmcnt(1)
  global_load_dwordx4 v[84:87], v[16:17], off nt
  v_add_co_u32 v16, vcc, 6912, v16
  s_nop 1
  v_addc_co_u32 v17, vcc, 0, v17, vcc
  s_waitcnt vmcnt(1)
  global_load_dwordx4 v[88:91], v[16:17], off nt
  v_add_co_u32 v16, vcc, 6912, v16
  s_nop 1
  v_addc_co_u32 v17, vcc, 0, v17, vcc
  s_waitcnt vmcnt(1)
  global_load_dwordx4 v[92:95], v[16:17], off nt
  v_add_co_u32 v16, vcc, 6912, v16
  s_nop 1
  v_addc_co_u32 v17, vcc, 0, v17, vcc
  s_waitcnt vmcnt(1)
  global_load_dwordx4 v[96:99], v[16:17], off nt
  v_add_co_u32 v16, vcc, 6912, v16
  s_nop 1
  v_addc_co_u32 v17, vcc, 0, v17, vcc
  s_waitcnt vmcnt(1)
  global_load_dwordx4 v[100:103], v[16:17], off nt
  v_lshl_add_u32 v22, v0, 4, s29
  v_lshl_add_u32 v23, v2, 8, s29
  v_bfe_u32 v18, v0, 3, 1
  v_lshl_add_u32 v23, v18, 10, v23
  v_bfe_u32 v18, v0, 2, 1
  v_lshl_add_u32 v23, v18, 7, v23
  v_and_b32 v18, 3, v0
  v_lshl_add_u32 v23, v18, 3, v23
  s_waitcnt vmcnt(12)
  ds_write_b128 v22, v[40:43] offset:0
  ds_write_b128 v22, v[44:47] offset:1024
  ds_write_b128 v22, v[48:51] offset:2048
  ds_write_b128 v22, v[52:55] offset:3072
  ds_read_b64_tr_b16 v[40:41], v23 offset:0
  ds_read_b64_tr_b16 v[42:43], v23 offset:2048
  ds_read_b64_tr_b16 v[44:45], v23 offset:32
  ds_read_b64_tr_b16 v[46:47], v23 offset:2080
  ds_read_b64_tr_b16 v[48:49], v23 offset:64
  ds_read_b64_tr_b16 v[50:51], v23 offset:2112
  ds_read_b64_tr_b16 v[52:53], v23 offset:96
  ds_read_b64_tr_b16 v[54:55], v23 offset:2144
  s_waitcnt lgkmcnt(0)
  s_waitcnt vmcnt(8)
  ds_write_b128 v22, v[56:59] offset:4096
  ds_write_b128 v22, v[60:63] offset:5120
  ds_write_b128 v22, v[64:67] offset:6144
  ds_write_b128 v22, v[68:71] offset:7168
  ds_read_b64_tr_b16 v[56:57], v23 offset:4096
  ds_read_b64_tr_b16 v[58:59], v23 offset:6144
  ds_read_b64_tr_b16 v[60:61], v23 offset:4128
  ds_read_b64_tr_b16 v[62:63], v23 offset:6176
  ds_read_b64_tr_b16 v[64:65], v23 offset:4160
  ds_read_b64_tr_b16 v[66:67], v23 offset:6208
  ds_read_b64_tr_b16 v[68:69], v23 offset:4192
  ds_read_b64_tr_b16 v[70:71], v23 offset:6240
  s_waitcnt lgkmcnt(0)
  s_waitcnt vmcnt(4)
  ds_write_b128 v22, v[72:75] offset:0
  ds_write_b128 v22, v[76:79] offset:1024
  ds_write_b128 v22, v[80:83] offset:2048
  ds_write_b128 v22, v[84:87] offset:3072
  ds_read_b64_tr_b16 v[72:73], v23 offset:0
  ds_read_b64_tr_b16 v[74:75], v23 offset:2048
  ds_read_b64_tr_b16 v[76:77], v23 offset:32
  ds_read_b64_tr_b16 v[78:79], v23 offset:2080
  ds_read_b64_tr_b16 v[80:81], v23 offset:64
  ds_read_b64_tr_b16 v[82:83], v23 offset:2112
  ds_read_b64_tr_b16 v[84:85], v23 offset:96
  ds_read_b64_tr_b16 v[86:87], v23 offset:2144
  s_waitcnt lgkmcnt(0)
  s_waitcnt vmcnt(0)
  ds_write_b128 v22, v[88:91] offset:4096
  ds_write_b128 v22, v[92:95] offset:5120
  ds_write_b128 v22, v[96:99] offset:6144
  ds_write_b128 v22, v[100:103] offset:7168
  ds_read_b64_tr_b16 v[88:89], v23 offset:4096
  ds_read_b64_tr_b16 v[90:91], v23 offset:6144
  ds_read_b64_tr_b16 v[92:93], v23 offset:4128
  ds_read_b64_tr_b16 v[94:95], v23 offset:6176
  ds_read_b64_tr_b16 v[96:97], v23 offset:4160
  ds_read_b64_tr_b16 v[98:99], v23 offset:6208
  ds_read_b64_tr_b16 v[100:101], v23 offset:4192
  ds_read_b64_tr_b16 v[102:103], v23 offset:6240
  s_waitcnt lgkmcnt(0)
  s_cmp_lg_u32 s3, 1
  s_cbranch_scc1 Lmid_154
  s_mov_b32 s31, s18
  s_mov_b32 s17, 224
  s_cmp_eq_u32 s33, 2
  s_cselect_b32 s17, 240, s17
  s_cmp_eq_u32 s33, 3
  s_cselect_b32 s17, 256, s17
  v_mov_b32 v8, 0
  s_mov_b32 s34, 0
Lw_155:
  ds_read_b32 v9, v8 offset:0
  s_waitcnt lgkmcnt(0)
  v_readfirstlane_b32 s35, v9
  s_nop 0
  s_cmp_ge_u32 s35, s17
  s_nop 1
  s_cbranch_scc1 Lwe_156
  s_sleep 4
  s_add_u32 s34, s34, 1
  s_cmp_lt_u32 s34, 800000
  s_cbranch_scc1 Lw_155
Lwe_156:
  s_lshl_b32 s18, s5, 12
  s_add_u32 s20, s18, 131072
  s_add_u32 s20, s62, s20
  s_addc_u32 s21, s63, 0
  v_lshlrev_b32 v7, 4, v0
  s_mov_b32 s34, 0
Lp_157:
  global_load_dwordx4 v[8:11], v7, s[20:21] offset:0 sc1
  global_load_dwordx4 v[12:15], v7, s[20:21] offset:1024 sc1
  global_load_dwordx4 v[16:19], v7, s[20:21] offset:2048 sc1
  global_load_dwordx4 v[20:23], v7, s[20:21] offset:3072 sc1
Lpf_159:
  s_waitcnt vmcnt(0)
  v_max_u32 v24, v9, v11
  v_max3_u32 v24, v24, v13, v15
  v_max3_u32 v24, v24, v17, v19
  v_max3_u32 v24, v24, v21, v23
  v_min_u32 v25, v9, v11
  v_min3_u32 v25, v25, v13, v15
  v_min3_u32 v25, v25, v17, v19
  v_min3_u32 v25, v25, v21, v23
  v_xor_b32 v24, s32, v24
  v_xor_b32 v25, s32, v25
  v_or_b32 v24, v24, v25
  v_cmp_ne_u32 vcc, 0, v24
  s_nop 0
  s_cmp_eq_u64 vcc, 0
  s_nop 1
  s_cbranch_scc1 Lpe_158
  s_sleep 8
  s_add_u32 s34, s34, 1
  s_cmp_lt_u32 s34, 200000
  s_cbranch_scc1 Lp_157
Lpe_158:
  v_add_f32 v8, v8, v12
  v_add_f32 v10, v10, v14
  v_add_f32 v16, v16, v20
  v_add_f32 v18, v18, v22
  v_add_f32 v8, v8, v16
  v_add_f32 v10, v10, v18
  v_cvt_pk_bf16_f32 v6, v8, v10
  v_lshlrev_b32 v7, 2, v0
  ds_write_b32 v7, v6 offset:128
  v_mov_b32 v6, 0
  s_mov_b32 s34, 0
Lw_160:
  ds_read_b32 v7, v6 offset:4
  s_waitcnt lgkmcnt(0)
  v_readfirstlane_b32 s35, v7
  s_nop 0
  s_cmp_eq_u32 s35, 4
  s_nop 1
  s_cbranch_scc1 Lwe_161
  s_sleep 1
  s_add_u32 s34, s34, 1
  s_cmp_lt_u32 s34, 800000
  s_cbranch_scc1 Lw_160
Lwe_161:
  v_mov_b32 v7, s32
  ds_write_b32 v6, v7 offset:24
  v_mov_b32 v6, 0
  v_mov_b32 v7, 1
  ds_write_b32 v6, v7 offset:8
  s_mov_b32 s18, s31
Lmid_154:
  s_branch L_tw_done
L_tw_none:
  s_sub_u32 s28, s7, 94
  s_mov_b32 s23, 1
  s_cmp_eq_u32 s3, 1
  s_cbranch_scc1 L_np
  s_add_u32 s21, s28, 128
  s_cmp_eq_u32 s3, 3
  s_cbranch_scc1 L_h0_unit
  s_cmp_eq_u32 s3, 2
  s_cbranch_scc1 L_fr2
  s_add_u32 s21, s28, 162
  s_cmp_lt_u32 s28, 33
  s_cbranch_scc1 L_h0_unit
  s_add_u32 s20, s62, 1773568
  s_addc_u32 s21, s63, 0
  s_mov_b32 s24, -1
  s_mov_b32 s25, -1
  s_load_dword s72, s[20:21], -4096 glc
  s_load_dword s73, s[20:21], 4096 glc
  s_waitcnt lgkmcnt(0)
  s_memtime s[64:65]
  s_waitcnt lgkmcnt(0)
  s_load_dword s72, s[20:21], 0 glc
  s_load_dword s73, s[20:21], 512 glc
  s_load_dword s74, s[20:21], 1024 glc
  s_load_dword s75, s[20:21], 1536 glc
  s_load_dword s76, s[20:21], 2048 glc
  s_load_dword s77, s[20:21], 2560 glc
  s_load_dword s78, s[20:21], 3072 glc
  s_load_dword s79, s[20:21], 3584 glc
  s_waitcnt lgkmcnt(7)
  s_memtime s[66:67]
  s_waitcnt lgkmcnt(0)
  s_sub_u32 s66, s66, s64
  s_min_u32 s24, s24, s66
  s_memtime s[64:65]
  s_waitcnt lgkmcnt(0)
  s_load_dword s72, s[20:21], 8192 glc
  s_load_dword s73, s[20:21], 8704 glc
  s_load_dword s74, s[20:21], 9216 glc
  s_load_dword s75, s[20:21], 9728 glc
  s_load_dword s76, s[20:21], 10240 glc
  s_load_dword s77, s[20:21], 10752 glc
  s_load_dword s78, s[20:21], 11264 glc
  s_load_dword s79, s[20:21], 11776 glc
  s_waitcnt lgkmcnt(7)
  s_memtime s[66:67]
  s_waitcnt lgkmcnt(0)
  s_sub_u32 s66, s66, s64
  s_min_u32 s25, s25, s66
  s_memtime s[64:65]
  s_waitcnt lgkmcnt(0)
  s_load_dword s72, s[20:21], 8320 glc
  s_load_dword s73, s[20:21], 8832 glc
  s_load_dword s74, s[20:21], 9344 glc
  s_load_dword s75, s[20:21], 9856 glc
  s_load_dword s76, s[20:21], 10368 glc
  s_load_dword s77, s[20:21], 10880 glc
  s_load_dword s78, s[20:21], 11392 glc
  s_load_dword s79, s[20:21], 11904 glc
  s_waitcnt lgkmcnt(7)
  s_memtime s[66:67]
  s_waitcnt lgkmcnt(0)
  s_sub_u32 s66, s66, s64
  s_min_u32 s25, s25, s66
  s_memtime s[64:65]
  s_waitcnt lgkmcnt(0)
  s_load_dword s72, s[20:21], 128 glc
  s_load_dword s73, s[20:21], 640 glc
  s_load_dword s74, s[20:21], 1152 glc
  s_load_dword s75, s[20:21], 1664 glc
  s_load_dword s76, s[20:21], 2176 glc
  s_load_dword s77, s[20:21], 2688 glc
  s_load_dword s78, s[20:21], 3200 glc
  s_load_dword s79, s[20:21], 3712 glc
  s_waitcnt lgkmcnt(7)
  s_memtime s[66:67]
  s_waitcnt lgkmcnt(0)
  s_sub_u32 s66, s66, s64
  s_min_u32 s24, s24, s66
  s_memtime s[64:65]
  s_waitcnt lgkmcnt(0)
  s_load_dword s72, s[20:21], 256 glc
  s_load_dword s73, s[20:21], 768 glc
  s_load_dword s74, s[20:21], 1280 glc
  s_load_dword s75, s[20:21], 1792 glc
  s_load_dword s76, s[20:21], 2304 glc
  s_load_dword s77, s[20:21], 2816 glc
  s_load_dword s78, s[20:21], 3328 glc
  s_load_dword s79, s[20:21], 3840 glc
  s_waitcnt lgkmcnt(7)
  s_memtime s[66:67]
  s_waitcnt lgkmcnt(0)
  s_sub_u32 s66, s66, s64
  s_min_u32 s24, s24, s66
  s_memtime s[64:65]
  s_waitcnt lgkmcnt(0)
  s_load_dword s72, s[20:21], 8448 glc
  s_load_dword s73, s[20:21], 8960 glc
  s_load_dword s74, s[20:21], 9472 glc
  s_load_dword s75, s[20:21], 9984 glc
  s_load_dword s76, s[20:21], 10496 glc
  s_load_dword s77, s[20:21], 11008 glc
  s_load_dword s78, s[20:21], 11520 glc
  s_load_dword s79, s[20:21], 12032 glc
  s_waitcnt lgkmcnt(7)
  s_memtime s[66:67]
  s_waitcnt lgkmcnt(0)
  s_sub_u32 s66, s66, s64
  s_min_u32 s25, s25, s66
  s_memtime s[64:65]
  s_waitcnt lgkmcnt(0)
  s_load_dword s72, s[20:21], 8576 glc
  s_load_dword s73, s[20:21], 9088 glc
  s_load_dword s74, s[20:21], 9600 glc
  s_load_dword s75, s[20:21], 10112 glc
  s_load_dword s76, s[20:21], 10624 glc
  s_load_dword s77, s[20:21], 11136 glc
  s_load_dword s78, s[20:21], 11648 glc
  s_load_dword s79, s[20:21], 12160 glc
  s_waitcnt lgkmcnt(7)
  s_memtime s[66:67]
  s_waitcnt lgkmcnt(0)
  s_sub_u32 s66, s66, s64
  s_min_u32 s25, s25, s66
  s_memtime s[64:65]
  s_waitcnt lgkmcnt(0)
  s_load_dword s72, s[20:21], 384 glc
  s_load_dword s73, s[20:21], 896 glc
  s_load_dword s74, s[20:21], 1408 glc
  s_load_dword s75, s[20:21], 1920 glc
  s_load_dword s76, s[20:21], 2432 glc
  s_load_dword s77, s[20:21], 2944 glc
  s_load_dword s78, s[20:21], 3456 glc
  s_load_dword s79, s[20:21], 3968 glc
  s_waitcnt lgkmcnt(7)
  s_memtime s[66:67]
  s_waitcnt lgkmcnt(0)
  s_sub_u32 s66, s66, s64
  s_min_u32 s24, s24, s66
  s_cmp_lt_u32 s25, s24
  s_cselect_b32 s18, 8192, 0
  s_add_u32 s18, s18, 4096
  v_mov_b32 v28, -1
  v_mov_b32 v29, -1
  v_mov_b32 v30, -1
  v_mov_b32 v31, -1
  v_lshl_add_u32 v5, v0, 4, s18
  s_add_u32 s24, s62, 1310720
  s_addc_u32 s25, s63, 0
  global_store_dwordx4 v5, v[28:31], s[24:25] sc1
  global_store_dwordx4 v5, v[28:31], s[24:25] offset:1024 sc1
  s_mov_b32 exec_hi, 0
  global_store_dwordx4 v5, v[28:31], s[24:25] offset:2048 sc1
  s_mov_b32 exec_hi, -1
  s_add_u32 s24, s24, 16384
  s_addc_u32 s25, s25, 0
  global_store_dwordx4 v5, v[28:31], s[24:25] sc1
  global_store_dwordx4 v5, v[28:31], s[24:25] offset:1024 sc1
  s_mov_b32 exec_hi, 0
  global_store_dwordx4 v5, v[28:31], s[24:25] offset:2048 sc1
  s_mov_b32 exec_hi, -1
  s_add_u32 s24, s24, 16384
  s_addc_u32 s25, s25, 0
  global_store_dwordx4 v5, v[28:31], s[24:25] sc1
  global_store_dwordx4 v5, v[28:31], s[24:25] offset:1024 sc1
  s_mov_b32 exec_hi, 0
  global_store_dwordx4 v5, v[28:31], s[24:25] offset:2048 sc1
  s_mov_b32 exec_hi, -1
  s_add_u32 s24, s24, 16384
  s_addc_u32 s25, s25, 0
  global_store_dwordx4 v5, v[28:31], s[24:25] sc1
  global_store_dwordx4 v5, v[28:31], s[24:25] offset:1024 sc1
  s_mov_b32 exec_hi, 0
  global_store_dwordx4 v5, v[28:31], s[24:25] offset:2048 sc1
  s_mov_b32 exec_hi, -1
  s_add_u32 s24, s24, 16384
  s_addc_u32 s25, s25, 0
  global_store_dwordx4 v5, v[28:31], s[24:25] sc1
  global_store_dwordx4 v5, v[28:31], s[24:25] offset:1024 sc1
  s_mov_b32 exec_hi, 0
  global_store_dwordx4 v5, v[28:31], s[24:25] offset:2048 sc1
  s_mov_b32 exec_hi, -1
  s_add_u32 s24, s24, 16384
  s_addc_u32 s25, s25, 0
  global_store_dwordx4 v5, v[28:31], s[24:25] sc1
  global_store_dwordx4 v5, v[28:31], s[24:25] offset:1024 sc1
  s_mov_b32 exec_hi, 0
  global_store_dwordx4 v5, v[28:31], s[24:25] offset:2048 sc1
  s_mov_b32 exec_hi, -1
  s_add_u32 s24, s24, 16384
  s_addc_u32 s25, s25, 0
  global_store_dwordx4 v5, v[28:31], s[24:25] sc1
  global_store_dwordx4 v5, v[28:31], s[24:25] offset:1024 sc1
  s_mov_b32 exec_hi, 0
  global_store_dwordx4 v5, v[28:31], s[24:25] offset:2048 sc1
  s_mov_b32 exec_hi, -1
  s_add_u32 s24, s24, 16384
  s_addc_u32 s25, s25, 0
  global_store_dwordx4 v5, v[28:31], s[24:25] sc1
  global_store_dwordx4 v5, v[28:31], s[24:25] offset:1024 sc1
  s_mov_b32 exec_hi, 0
  global_store_dwordx4 v5, v[28:31], s[24:25] offset:2048 sc1
  s_mov_b32 exec_hi, -1
  s_add_u32 s24, s24, 16384
  s_addc_u32 s25, s25, 0
  s_add_u32 s20, s62, 329728
  s_addc_u32 s21, s63, 0
  v_mov_b32 v8, s18
  v_mov_b32 v9, s32
  v_mov_b32 v10, s18
  v_mov_b32 v11, s32
  v_lshlrev_b32 v3, 4, v0
  s_waitcnt vmcnt(0)
  s_mov_b64 exec, 0xff
  global_store_dwordx4 v3, v[8:11], s[20:21] sc1
  s_mov_b64 exec, -1
  s_endpgm
L_fr2:
  s_add_u32 s21, s28, 187
  s_cmp_ge_u32 s28, 8
  s_cbranch_scc1 L_h0_unit
  s_endpgm
L_np:
  s_cmp_lg_u32 s3, 1
  s_cbranch_scc1 Lmid_162
  s_mov_b32 s31, s18
  s_mov_b32 s17, 224
  s_cmp_eq_u32 s33, 2
  s_cselect_b32 s17, 240, s17
  s_cmp_eq_u32 s33, 3
  s_cselect_b32 s17, 256, s17
  v_mov_b32 v8, 0
  s_mov_b32 s34, 0
Lw_163:
  ds_read_b32 v9, v8 offset:0
  s_waitcnt lgkmcnt(0)
  v_readfirstlane_b32 s35, v9
  s_nop 0
  s_cmp_ge_u32 s35, s17
  s_nop 1
  s_cbranch_scc1 Lwe_164
  s_sleep 4
  s_add_u32 s34, s34, 1
  s_cmp_lt_u32 s34, 800000
  s_cbranch_scc1 Lw_163
Lwe_164:
  s_lshl_b32 s18, s5, 12
  s_add_u32 s20, s18, 131072
  s_add_u32 s20, s62, s20
  s_addc_u32 s21, s63, 0
  v_lshlrev_b32 v7, 4, v0
  s_mov_b32 s34, 0
Lp_165:
  global_load_dwordx4 v[8:11], v7, s[20:21] offset:0 sc1
  global_load_dwordx4 v[12:15], v7, s[20:21] offset:1024 sc1
  global_load_dwordx4 v[16:19], v7, s[20:21] offset:2048 sc1
  global_load_dwordx4 v[20:23], v7, s[20:21] offset:3072 sc1
Lpf_167:
  s_waitcnt vmcnt(0)
  v_max_u32 v24, v9, v11
  v_max3_u32 v24, v24, v13, v15
  v_max3_u32 v24, v24, v17, v19
  v_max3_u32 v24, v24, v21, v23
  v_min_u32 v25, v9, v11
  v_min3_u32 v25, v25, v13, v15
  v_min3_u32 v25, v25, v17, v19
  v_min3_u32 v25, v25, v21, v23
  v_xor_b32 v24, s32, v24
  v_xor_b32 v25, s32, v25
  v_or_b32 v24, v24, v25
  v_cmp_ne_u32 vcc, 0, v24
  s_nop 0
  s_cmp_eq_u64 vcc, 0
  s_nop 1
  s_cbranch_scc1 Lpe_166
  s_sleep 8
  s_add_u32 s34, s34, 1
  s_cmp_lt_u32 s34, 200000
  s_cbranch_scc1 Lp_165
Lpe_166:
  v_add_f32 v8, v8, v12
  v_add_f32 v10, v10, v14
  v_add_f32 v16, v16, v20
  v_add_f32 v18, v18, v22
  v_add_f32 v8, v8, v16
  v_add_f32 v10, v10, v18
  v_cvt_pk_bf16_f32 v6, v8, v10
  v_lshlrev_b32 v7, 2, v0
  ds_write_b32 v7, v6 offset:128
  v_mov_b32 v6, 0
  s_mov_b32 s34, 0
Lw_168:
  ds_read_b32 v7, v6 offset:4
  s_waitcnt lgkmcnt(0)
  v_readfirstlane_b32 s35, v7
  s_nop 0
  s_cmp_eq_u32 s35, 4
  s_nop 1
  s_cbranch_scc1 Lwe_169
  s_sleep 1
  s_add_u32 s34, s34, 1
  s_cmp_lt_u32 s34, 800000
  s_cbranch_scc1 Lw_168
Lwe_169:
  v_mov_b32 v7, s32
  ds_write_b32 v6, v7 offset:24
  v_mov_b32 v6, 0
  v_mov_b32 v7, 1
  ds_write_b32 v6, v7 offset:8
  s_mov_b32 s18, s31
Lmid_162:
  s_endpgm
L_tw_done:
  s_waitcnt vmcnt(0)
  s_cmp_lg_u32 s3, 3
  s_cbranch_scc1 L_tail
L_ctrl:
  s_lshl_b32 s18, s5, 11
  s_add_u32 s22, s18, 262144
  s_add_u32 s22, s62, s22
  s_addc_u32 s23, s63, 0
  s_mov_b32 s24, 0
  s_cmp_eq_u32 s33, 1
  s_cselect_b32 s24, 0, s24
  s_cmp_eq_u32 s33, 2
  s_cselect_b32 s24, 0, s24
  s_cmp_eq_u32 s33, 3
  s_cselect_b32 s24, 0, s24
  s_cmp_eq_u32 s33, 4
  s_cselect_b32 s24, 0, s24
  s_mov_b32 s26, 0
  s_mov_b32 s27, 0
  s_mov_b32 s31, 0
  s_mov_b64 s[66:67], 0x1ffff
  s_mov_b32 s72, 0x7fffffff
  s_mov_b32 s73, 0x1ffff
  s_mov_b32 s74, 0
  s_not_b32 s18, s32
  v_mov_b32 v21, s18
  v_mov_b32 v23, s18
  v_mov_b32 v6, 0
  s_lshl_b32 s18, s6, 7
  v_lshl_add_u32 v7, v0, 3, s18
  v_lshlrev_b32 v16, 7, v0
  v_mov_b32 v9, s32
  s_lshl_b32 s18, s5, 11
  s_sub_u32 s18, 67584, s18
  v_writelane_b32 v16, s18, 16
  s_mov_b32 s17, 240
  s_cmp_eq_u32 s33, 1
  s_cselect_b32 s17, 224, s17
  s_cmp_eq_u32 s33, 3
  s_cselect_b32 s17, 272, s17
  v_mov_b32 v10, 0
  s_mov_b32 s34, 0
Lw_170:
  ds_read_b32 v11, v10 offset:0
  s_waitcnt lgkmcnt(0)
  v_readfirstlane_b32 s35, v11
  s_nop 0
  s_cmp_ge_u32 s35, s17
  s_nop 1
  s_cbranch_scc1 Lwe_171
  s_sleep 4
  s_add_u32 s34, s34, 1
  s_cmp_lt_u32 s34, 800000
  s_cbranch_scc1 Lw_170
Lwe_171:
  s_memrealtime s[80:81]
  s_sub_u32 s25, s35, s24
  s_waitcnt lgkmcnt(0)
  s_sub_u32 s18, s80, s76
  s_sub_i32 s18, 1440, s18
  s_max_i32 s18, s18, 60
  s_mul_i32 s18, s18, 69
  s_lshr_b32 s18, s18, 8
  s_add_u32 s17, s18, s35
  s_min_u32 s17, s17, 384
  v_mov_b32 v10, 0
  s_mov_b32 s34, 0
Lw_172:
  ds_read_b32 v11, v10 offset:0
  s_waitcnt lgkmcnt(0)
  v_readfirstlane_b32 s35, v11
  s_nop 0
  s_cmp_ge_u32 s35, s17
  s_nop 1
  s_cbranch_scc1 Lwe_173
  s_sleep 2
  s_add_u32 s34, s34, 1
  s_cmp_lt_u32 s34, 800000
  s_cbranch_scc1 Lw_172
Lwe_173:
  s_memrealtime s[82:83]
  s_sub_u32 s16, s35, s24
  s_waitcnt lgkmcnt(0)
  s_branch L_c_dopub
L_c_loop:
  ds_read_b32 v12, v6 offset:0
  s_waitcnt lgkmcnt(0)
  v_readfirstlane_b32 s16, v12
  s_nop 0
  s_cmp_ge_u32 s16, s72
  s_cselect_b32 s18, 0x1ffff, s73
  s_cselect_b32 s67, s74, 0
  s_and_b32 s66, s66, s18
  s_cmp_lg_u64 s[66:67], 0
  s_cbranch_scc1 L_c_ld
  s_sleep 4
  s_branch L_c_chk
L_c_ld:
  s_mov_b64 exec, s[66:67]
  global_load_dwordx4 v[20:23], v16, s[22:23] sc1
  s_waitcnt vmcnt(0)
  s_mov_b64 exec, -1
  v_xor_b32 v12, s32, v21
  v_xor_b32 v13, s32, v23
  v_or_b32 v12, v12, v13
  v_and_b32 v12, 0xffff, v12
  v_cmp_ne_u32 vcc, 0, v12
  s_nop 0
  s_and_b32 s74, s74, vcc_hi
L_c_chk:
  s_mov_b64 exec, 0x1ffff
  v_cmp_eq_u32 vcc, s32, v21
  v_cmp_eq_u32 s[64:65], s32, v23
  s_nop 0
  s_and_b32 s64, s64, vcc_lo
  s_andn2_b32 s66, 0x1ffff, s64
  s_and_b32 exec_lo, s64, 0x10000
  ds_write_b32 v6, v20 offset:28
  s_mov_b64 exec, -1
  s_bfe_u32 s18, s64, 0x80008
  s_cmp_eq_u32 s27, 3
  s_cbranch_scc1 L_c_ml
  s_cmp_eq_u32 s27, 2
  s_cbranch_scc1 L_c_sc
  s_branch L_c_pub
L_c_dopub:
  s_sub_u32 s35, s82, s80
  s_sub_u32 s19, s16, s25
  s_max_i32 s19, s19, 8
  v_cvt_f32_u32 v12, s35
  v_cvt_f32_u32 v13, s19
  v_rcp_f32 v13, v13
  s_mov_b32 s35, 1065353216
  s_cmp_eq_u32 s33, 1
  s_cselect_b32 s35, 1064178811, s35
  s_cmp_eq_u32 s33, 2
  s_cselect_b32 s35, 1065353216, s35
  s_cmp_eq_u32 s33, 3
  s_cselect_b32 s35, 1065353216, s35
  s_cmp_eq_u32 s33, 4
  s_cselect_b32 s35, 1065353216, s35
  v_mul_f32 v12, v12, v13
  v_mul_f32 v12, s35, v12
  v_subrev_f32 v12, 1080662426, v12
  v_mul_f32 v12, 1048576000, v12
  v_add_f32 v12, 1080662426, v12
  v_max_f32 v12, 1.0, v12
  v_min_f32 v12, 0x41800000, v12
  s_sub_i32 s19, 432, s16
  v_cvt_f32_i32 v13, s19
  v_mul_f32 v13, v13, v12
  v_cvt_i32_f32 v13, v13
  s_mov_b32 s35, 0
  s_cmp_eq_u32 s33, 1
  s_cselect_b32 s35, 40, s35
  s_cmp_eq_u32 s33, 2
  s_cselect_b32 s35, 45, s35
  s_cmp_eq_u32 s33, 3
  s_cselect_b32 s35, 0, s35
  s_cmp_eq_u32 s33, 4
  s_cselect_b32 s35, 0, s35
  s_and_b32 s19, s2, 1
  s_mul_i32 s19, s19, 20
  s_add_u32 s35, s35, s19
  s_add_u32 s35, s35, s82
  v_add_u32 v13, s35, v13
  s_sub_u32 s18, s82, s76
  s_sub_i32 s18, 1665, s18
  s_max_i32 s18, s18, 240
  s_mul_i32 s18, s18, 71
  s_lshr_b32 s18, s18, 8
  s_add_u32 s18, s18, s16
  s_add_u32 s19, s18, 39
  s_lshr_b32 s19, s19, 3
  s_sub_i32 s19, s19, 50
  s_max_i32 s19, s19, 0
  s_min_i32 s19, s19, 9
  s_lshl_b32 s75, s19, 3
  s_add_u32 s75, s75, 400
  s_sub_u32 s18, s18, 36
  s_min_u32 s75, s75, s18
  s_add_u32 s75, s75, s24
  v_mov_b32 v14, s19
  ds_write_b32 v6, v14 offset:32
  v_min_f32 v12, 0x417f0000, v12
  v_mul_f32 v12, 0x43800000, v12
  v_cvt_u32_f32 v12, v12
  v_lshl_or_b32 v12, v14, 12, v12
  v_lshl_or_b32 v8, v13, 16, v12
  s_mov_b64 exec, 0xffff
  global_store_dwordx2 v7, v[8:9], s[22:23] offset:1024 sc1
  s_mov_b64 exec, -1
  s_mov_b32 s27, 1
  s_cmp_lg_u32 s33, 1
  s_cbranch_scc1 L_c_now3
  s_mov_b32 s8, s44
  s_and_b32 s9, s45, 0xffff
  s_mov_b32 s10, 5242880
  s_mov_b32 s11, 0x20000
  v_mul_u32_u24 v3, 1280, v2
  v_lshl_add_u32 v3, v1, 4, v3
  s_mul_i32 s18, s28, 655360
  s_lshl_b32 s19, s29, 8
  s_add_u32 s18, s18, s19
  s_mul_i32 s19, s3, 40960
  s_add_u32 s18, s18, s19
  s_add_u32 s18, s18, 491520
  buffer_load_dwordx4 v[136:139], v3, s[8:11], s18 offen nt
  s_add_u32 s18, s18, 5120
  buffer_load_dwordx4 v[140:143], v3, s[8:11], s18 offen nt
  s_add_u32 s18, s18, 5120
  buffer_load_dwordx4 v[144:147], v3, s[8:11], s18 offen nt
  s_add_u32 s18, s18, 5120
  buffer_load_dwordx4 v[148:151], v3, s[8:11], s18 offen nt
  s_add_u32 s18, s18, 5120
  buffer_load_dwordx4 v[152:155], v3, s[8:11], s18 offen nt
  s_add_u32 s18, s18, 5120
  buffer_load_dwordx4 v[156:159], v3, s[8:11], s18 offen nt
  s_waitcnt vmcnt(5)
  s_add_u32 s18, s18, 5120
  buffer_load_dwordx4 v[160:163], v3, s[8:11], s18 offen nt
  s_waitcnt vmcnt(5)
  s_add_u32 s18, s18, 5120
  buffer_load_dwordx4 v[164:167], v3, s[8:11], s18 offen nt
L_c_now3:
  v_mov_b32 v10, 0
  s_mov_b32 s34, 0
Lw_174:
  ds_read_b32 v11, v10 offset:0
  s_waitcnt lgkmcnt(0)
  v_readfirstlane_b32 s35, v11
  s_nop 0
  s_cmp_ge_u32 s35, s75
  s_nop 1
  s_cbranch_scc1 Lwe_175
  s_sleep 2
  s_add_u32 s34, s34, 1
  s_cmp_lt_u32 s34, 800000
  s_cbranch_scc1 Lw_174
Lwe_175:
  s_branch L_c_loop
L_c_pub:
  s_cmp_lg_u32 s18, 0xff
  s_cbranch_scc1 L_c_ml
  v_mov_b32_dpp v12, v20 row_ror:8 row_mask:0xf bank_mask:0xf
  s_nop 0
  v_readfirstlane_b32 s35, v12
  s_nop 0
  s_and_b32 s35, s35, 0xffff0000
  v_bfe_u32 v17, v12, 12, 4
  v_and_b32 v13, 0xfff, v12
  v_subrev_u32 v12, s35, v12
  v_ashrrev_i32 v12, 16, v12
  v_cvt_f32_u32 v13, v13
  v_cvt_f32_i32 v12, v12
  v_max_f32 v13, 0x43800000, v13
  v_rcp_f32 v13, v13
  s_nop 0
  v_mul_f32 v13, 0x42000000, v13
  v_cvt_f32_u32 v18, v17
  v_add_f32 v18, 3239994982, v18
  v_mul_f32 v14, v12, v13
  v_mov_b32 v15, v13
  s_nop 0
  v_add_f32_dpp v14, v14, v14 quad_perm:[1,0,3,2] row_mask:0xf bank_mask:0xf
  v_add_f32_dpp v15, v15, v15 quad_perm:[1,0,3,2] row_mask:0xf bank_mask:0xf
  s_nop 0
  v_add_f32_dpp v14, v14, v14 quad_perm:[2,3,0,1] row_mask:0xf bank_mask:0xf
  v_add_f32_dpp v15, v15, v15 quad_perm:[2,3,0,1] row_mask:0xf bank_mask:0xf
  s_nop 0
  v_add_f32_dpp v14, v14, v14 row_half_mirror row_mask:0xf bank_mask:0xf
  v_add_f32_dpp v15, v15, v15 row_half_mirror row_mask:0xf bank_mask:0xf
  v_add_f32 v14, 1117782016, v14
  v_rcp_f32 v15, v15
  s_nop 0
  v_mul_f32 v14, v14, v15
  v_sub_f32 v14, v14, v12
  v_mul_f32 v14, v14, v13
  v_subrev_f32 v14, 1092616192, v14
  v_mul_f32 v14, 1065353216, v14
  v_add_f32 v14, 1050757038, v14
  v_max_f32 v15, 0, v14
  v_min_f32 v15, 1060320051, v15
  v_sub_f32 v14, v14, v15
  v_max_f32 v15, v18, v14
  v_min_f32 v15, 1086115021, v15
  s_nop 1
  v_add_f32_dpp v15, v15, v15 quad_perm:[1,0,3,2] row_mask:0xf bank_mask:0xf
  s_nop 1
  v_add_f32_dpp v15, v15, v15 quad_perm:[2,3,0,1] row_mask:0xf bank_mask:0xf
  s_nop 1
  v_add_f32_dpp v15, v15, v15 row_half_mirror row_mask:0xf bank_mask:0xf
  v_fmac_f32 v14, 3191362028, v15
  v_max_f32 v15, v18, v14
  v_min_f32 v15, 1086115021, v15
  s_nop 1
  v_add_f32_dpp v15, v15, v15 quad_perm:[1,0,3,2] row_mask:0xf bank_mask:0xf
  s_nop 1
  v_add_f32_dpp v15, v15, v15 quad_perm:[2,3,0,1] row_mask:0xf bank_mask:0xf
  s_nop 1
  v_add_f32_dpp v15, v15, v15 row_half_mirror row_mask:0xf bank_mask:0xf
  v_fmac_f32 v14, 3191362028, v15
  v_max_f32 v15, v18, v14
  v_min_f32 v15, 1086115021, v15
  s_nop 1
  v_add_f32_dpp v15, v15, v15 quad_perm:[1,0,3,2] row_mask:0xf bank_mask:0xf
  s_nop 1
  v_add_f32_dpp v15, v15, v15 quad_perm:[2,3,0,1] row_mask:0xf bank_mask:0xf
  s_nop 1
  v_add_f32_dpp v15, v15, v15 row_half_mirror row_mask:0xf bank_mask:0xf
  v_fmac_f32 v14, 3191362028, v15
  v_max_f32 v15, v18, v14
  v_min_f32 v15, 1086115021, v15
  s_nop 1
  v_add_f32_dpp v15, v15, v15 quad_perm:[1,0,3,2] row_mask:0xf bank_mask:0xf
  s_nop 1
  v_add_f32_dpp v15, v15, v15 quad_perm:[2,3,0,1] row_mask:0xf bank_mask:0xf
  s_nop 1
  v_add_f32_dpp v15, v15, v15 row_half_mirror row_mask:0xf bank_mask:0xf
  v_fmac_f32 v14, 3191362028, v15
  v_max_f32 v14, v18, v14
  v_min_f32 v14, 1086115021, v14
  v_mov_b32 v15, v14
  v_rcp_f32 v18, v18
  s_nop 0
  v_add_f32_dpp v15, v15, v15 quad_perm:[1,0,3,2] row_mask:0xf bank_mask:0xf
  s_nop 1
  v_add_f32_dpp v15, v15, v15 quad_perm:[2,3,0,1] row_mask:0xf bank_mask:0xf
  s_nop 1
  v_add_f32_dpp v15, v15, v15 row_half_mirror row_mask:0xf bank_mask:0xf
  v_fmac_f32 v14, 0xbe000000, v15
  v_mul_f32 v15, 1043173168, v14
  v_mul_f32 v13, v18, v14
  v_max3_f32 v15, v15, v13, 1.0
  s_nop 1
  v_max_f32_dpp v15, v15, v15 quad_perm:[1,0,3,2] row_mask:0xf bank_mask:0xf
  s_nop 1
  v_max_f32_dpp v15, v15, v15 quad_perm:[2,3,0,1] row_mask:0xf bank_mask:0xf
  s_nop 1
  v_max_f32_dpp v15, v15, v15 row_half_mirror row_mask:0xf bank_mask:0xf
  v_rcp_f32 v15, v15
  s_nop 0
  v_mul_f32 v14, v14, v15
  v_add_f32 v14, 1092616192, v14
  s_nop 1
  v_add_f32_dpp v14, v14, v14 row_shr:1 row_mask:0xf bank_mask:0xf bound_ctrl:0
  s_nop 1
  v_add_f32_dpp v14, v14, v14 row_shr:2 row_mask:0xf bank_mask:0xf bound_ctrl:0
  s_nop 1
  v_add_f32_dpp v14, v14, v14 row_shr:4 row_mask:0xf bank_mask:0xf bound_ctrl:0
  v_rndne_f32 v14, v14
  v_cvt_u32_f32 v14, v14
  s_mov_b32 s35, 80
  v_writelane_b32 v14, s35, 7
  v_mov_b32 v15, 0
  s_nop 1
  v_mov_b32_dpp v15, v14 row_shr:1 row_mask:0xf bank_mask:0xf bound_ctrl:0
  v_sub_u32 v15, v14, v15
  v_cmp_lt_i32 vcc, v15, v17
  v_cmp_lt_i32 s[70:71], 16, v15
  s_nop 0
  s_or_b32 s18, vcc_lo, s70
  s_and_b32 s18, s18, 0xff
  s_cmp_lg_u32 s18, 0
  s_cselect_b64 vcc, -1, 0
  v_mov_b32 v12, 10
  v_cndmask_b32 v15, v15, v12, vcc
  v_min_u32 v12, 10, v15
  v_sub_u32 v13, 10, v12
  v_sub_u32 v14, v15, v12
  v_lshl_or_b32 v13, v14, 16, v13
  v_mov_b32 v17, v13
  s_nop 1
  v_add_u32_dpp v17, v17, v17 row_shr:1 row_mask:0xf bank_mask:0xf bound_ctrl:0
  s_nop 1
  v_add_u32_dpp v17, v17, v17 row_shr:2 row_mask:0xf bank_mask:0xf bound_ctrl:0
  s_nop 1
  v_add_u32_dpp v17, v17, v17 row_shr:4 row_mask:0xf bank_mask:0xf bound_ctrl:0
  v_readlane_b32 s69, v12, s6
  v_readlane_b32 s68, v14, s6
  v_readlane_b32 s18, v17, s6
  s_nop 0
  s_lshr_b32 s18, s18, 16
  s_sub_i32 s18, s18, 6
  v_and_b32 v18, 31, v0
  v_add_u32 v18, s18, v18
  v_mov_b32 v19, 0
  v_and_b32 v17, 0xffff, v17
  s_nop 0
  v_readlane_b32 s18, v17, 7
  s_nop 0
  s_sub_i32 s19, 80, s18
  v_add_u32 v12, s19, v18
  v_cmp_gt_i32 vcc, s18, v18
  s_nop 1
  v_cndmask_b32 v19, v19, v12, vcc
  v_readlane_b32 s18, v17, 6
  s_nop 0
  s_sub_i32 s19, 70, s18
  v_add_u32 v12, s19, v18
  v_cmp_gt_i32 vcc, s18, v18
  s_nop 1
  v_cndmask_b32 v19, v19, v12, vcc
  v_readlane_b32 s18, v17, 5
  s_nop 0
  s_sub_i32 s19, 60, s18
  v_add_u32 v12, s19, v18
  v_cmp_gt_i32 vcc, s18, v18
  s_nop 1
  v_cndmask_b32 v19, v19, v12, vcc
  v_readlane_b32 s18, v17, 4
  s_nop 0
  s_sub_i32 s19, 50, s18
  v_add_u32 v12, s19, v18
  v_cmp_gt_i32 vcc, s18, v18
  s_nop 1
  v_cndmask_b32 v19, v19, v12, vcc
  v_readlane_b32 s18, v17, 3
  s_nop 0
  s_sub_i32 s19, 40, s18
  v_add_u32 v12, s19, v18
  v_cmp_gt_i32 vcc, s18, v18
  s_nop 1
  v_cndmask_b32 v19, v19, v12, vcc
  v_readlane_b32 s18, v17, 2
  s_nop 0
  s_sub_i32 s19, 30, s18
  v_add_u32 v12, s19, v18
  v_cmp_gt_i32 vcc, s18, v18
  s_nop 1
  v_cndmask_b32 v19, v19, v12, vcc
  v_readlane_b32 s18, v17, 1
  s_nop 0
  s_sub_i32 s19, 20, s18
  v_add_u32 v12, s19, v18
  v_cmp_gt_i32 vcc, s18, v18
  s_nop 1
  v_cndmask_b32 v19, v19, v12, vcc
  v_readlane_b32 s18, v17, 0
  s_nop 0
  s_sub_i32 s19, 10, s18
  v_add_u32 v12, s19, v18
  v_cmp_gt_i32 vcc, s18, v18
  s_nop 1
  v_cndmask_b32 v19, v19, v12, vcc
  v_max_i32 v19, 0, v19
  v_min_i32 v19, 79, v19
  v_lshlrev_b32 v12, 2, v0
  s_mov_b64 exec, 0xff
  ds_write_b32 v12, v19 offset:96
  s_mov_b64 exec, -1
  s_lshl_b32 s35, s68, 8
  s_or_b32 s35, s35, s69
  s_add_u32 s72, s68, s69
  s_lshl_b32 s18, s72, 20
  s_or_b32 s35, s35, s18
  s_bitset1_b32 s35, 16
  v_mov_b32 v14, s35
  ds_write_b32 v6, v14 offset:32
  s_mov_b32 s27, 2
  s_lshl_b32 s72, s72, 3
  s_add_u32 s72, s72, 400
  s_add_u32 s72, s72, s24
  s_sub_u32 s18, 6, s68
  s_lshl_b32 s74, 63, s18
  s_and_b32 s74, s74, 63
  s_mul_i32 s18, s5, 8192
  s_add_u32 s18, s18, 98304
  v_lshl_add_u32 v12, v19, 7, s18
  s_mov_b32 exec_lo, 0
  v_mov_b32 v16, v12
  s_mov_b32 exec_lo, -1
  s_mov_b32 s68, 0
L_c_sc:
  ds_read_b32 v12, v6 offset:20
  s_waitcnt lgkmcnt(0)
  v_readfirstlane_b32 s18, v12
  s_nop 0
  s_cmp_lg_u32 s18, 8
  s_nop 1
  s_cbranch_scc1 L_c_ml
  v_lshlrev_b32 v12, 4, v0
  v_add_u32 v13, 57344, v12
  ds_read_b128 v[24:27], v13
  ds_read_b128 v[28:31], v13 offset:1024
  s_mul_i32 s18, s4, 1280
  s_add_u32 s20, s18, 360448
  s_add_u32 s20, s62, s20
  s_addc_u32 s21, s63, 0
  s_and_b32 s18, s32, 0xffff
  v_lshrrev_b32 v13, 3, v0
  v_add_u32 v14, 8, v13
  s_waitcnt lgkmcnt(0)
  v_or_b32 v24, s18, v24
  v_or_b32 v25, s18, v25
  v_or_b32 v26, s18, v26
  v_or_b32 v27, s18, v27
  v_or_b32 v28, s18, v28
  v_or_b32 v29, s18, v29
  v_or_b32 v30, s18, v30
  v_or_b32 v31, s18, v31
  v_cmp_gt_i32 vcc, s68, v13
  v_cmp_le_i32 s[70:71], s69, v13
  s_nop 0
  s_or_b64 vcc, vcc, s[70:71]
  s_nop 1
  s_cbranch_scc0 Lsp_176
  s_mov_b64 exec, vcc
  global_store_dwordx4 v12, v[24:27], s[20:21] offset:0 sc1
  s_mov_b64 exec, -1
Lsp_176:
  v_cmp_gt_i32 vcc, s68, v14
  v_cmp_le_i32 s[70:71], s69, v14
  s_nop 0
  s_or_b64 vcc, vcc, s[70:71]
  s_and_b64 vcc, vcc, 65535
  s_nop 0
  s_cbranch_scc0 Lsp_177
  s_mov_b64 exec, vcc
  global_store_dwordx4 v12, v[28:31], s[20:21] offset:1024 sc1
  s_mov_b64 exec, -1
Lsp_177:
  s_mov_b32 s27, 3
L_c_ml:
  s_cmp_lg_u32 s26, 0
  s_cbranch_scc1 L_c_s3
  s_and_b32 s18, s64, 0x100ff
  s_cmp_lg_u32 s18, 0x100ff
  s_cbranch_scc1 L_c_next
  s_mov_b32 s26, 1
  v_mov_b32 v18, v20
  v_mov_b32 v19, v22
  v_mov_b32 v10, v18
  s_nop 1
  v_max_f32_dpp v10, v10, v10 quad_perm:[1,0,3,2] row_mask:0xf bank_mask:0xf
  s_nop 1
  v_max_f32_dpp v10, v10, v10 quad_perm:[2,3,0,1] row_mask:0xf bank_mask:0xf
  s_nop 1
  v_max_f32_dpp v10, v10, v10 row_half_mirror row_mask:0xf bank_mask:0xf
  v_sub_f32 v18, v18, v10
  v_mul_f32 v18, 1069066811, v18
  v_exp_f32 v18, v18
  s_nop 0
  v_mul_f32 v19, v19, v18
  s_nop 1
  v_add_f32_dpp v19, v19, v19 quad_perm:[1,0,3,2] row_mask:0xf bank_mask:0xf
  s_nop 1
  v_add_f32_dpp v19, v19, v19 quad_perm:[2,3,0,1] row_mask:0xf bank_mask:0xf
  s_nop 1
  v_add_f32_dpp v19, v19, v19 row_half_mirror row_mask:0xf bank_mask:0xf
  v_rcp_f32 v11, v19
  s_nop 0
  v_fma_f32 v19, -v19, v11, 1.0
  v_fma_f32 v11, v19, v11, v11
  v_mov_b32 v12, 1
  s_mov_b64 exec, 1
  ds_write_b64 v6, v[10:11] offset:64
  ds_write_b32 v6, v12 offset:12
  s_mov_b64 exec, -1
L_c_s3:
  s_cmp_lg_u32 s27, 3
  s_cbranch_scc1 L_c_next
  s_cmp_eq_u32 s74, 0
  s_cbranch_scc1 L_c_done
L_c_next:
  s_add_u32 s31, s31, 1
  s_cmp_lt_u32 s31, 200000
  s_cbranch_scc1 L_c_loop
L_c_done:
  v_mov_b32 v12, 1
  ds_write_b32 v6, v12 offset:48
  s_cmp_eq_u32 s33, 0
  s_cbranch_scc1 L_end
  s_cmp_eq_u32 s33, 3
  s_cbranch_scc1 L_end
L_tail:
  v_mov_b32 v6, 0
  s_mov_b32 s34, 0
Lw_178:
  ds_read_b32 v7, v6 offset:8
  s_waitcnt lgkmcnt(0)
  v_readfirstlane_b32 s35, v7
  s_nop 0
  s_cmp_eq_u32 s35, 1
  s_nop 1
  s_cbranch_scc1 Lwe_179
  s_sleep 8
  s_add_u32 s34, s34, 1
  s_cmp_lt_u32 s34, 800000
  s_cbranch_scc1 Lw_178
Lwe_179:
  v_mov_b32 v14, 0
  s_mov_b32 s34, 0
Lw_180:
  ds_read_b32 v15, v14 offset:28
  s_waitcnt lgkmcnt(0)
  v_readfirstlane_b32 s35, v15
  s_nop 0
  s_cmp_ge_u32 s35, 1
  s_nop 1
  s_cbranch_scc1 Lwe_181
  s_sleep 8
  s_add_u32 s34, s34, 1
  s_cmp_lt_u32 s34, 800000
  s_cbranch_scc1 Lw_180
Lwe_181:
  s_cmp_eq_u32 s33, 2
  s_cbranch_scc1 L_tail_g
  v_and_b32 v8, 1, v0
  v_lshlrev_b32 v8, 4, v8
  v_mov_b32 v9, 0xffff
  v_lshlrev_b32 v9, v8, v9
  v_bfe_u32 v8, v0, 1, 2
  v_cmp_eq_u32 vcc, 0, v8
  s_nop 1
  v_cndmask_b32 v4, 0, v9, vcc
  v_cmp_eq_u32 vcc, 1, v8
  s_nop 1
  v_cndmask_b32 v5, 0, v9, vcc
  v_cmp_eq_u32 vcc, 2, v8
  s_nop 1
  v_cndmask_b32 v6, 0, v9, vcc
  v_cmp_eq_u32 vcc, 3, v8
  s_nop 1
  v_cndmask_b32 v7, 0, v9, vcc
  s_lshl_b32 s18, s28, 16
  s_add_u32 s20, s18, 786432
  s_add_u32 s20, s62, s20
  s_addc_u32 s21, s63, 0
  s_add_u32 s22, s20, 16384
  s_addc_u32 s23, s21, 0
  s_add_u32 s24, s22, 16384
  s_addc_u32 s25, s23, 0
  s_add_u32 s26, s24, 16384
  s_addc_u32 s27, s25, 0
  s_sub_u32 s22, s22, 4096
  s_subb_u32 s23, s23, 0
  s_sub_u32 s26, s26, 4096
  s_subb_u32 s27, s27, 0
  s_lshl_b32 s18, s28, 14
  s_lshl_b32 s19, s29, 9
  s_add_u32 s18, s18, s19
  s_add_u32 s30, s18, 1310720
  s_add_u32 s30, s62, s30
  s_addc_u32 s31, s63, 0
  v_lshrrev_b32 v3, 3, v0
  v_lshlrev_b32 v3, 9, v3
  v_and_b32 v8, 7, v0
  v_lshl_add_u32 v3, v8, 4, v3
  s_lshl_b32 s18, s3, 7
  v_add3_u32 v3, v3, s18, v15
  v_lshlrev_b32 v12, 5, v1
  v_lshl_add_u32 v12, v2, 4, v12
  s_lshl_b32 s18, s3, 9
  v_add_u32 v12, s18, v12
  v_lshlrev_b32 v13, 4, v0
  v_add_u32 v15, v15, v13
  v_lshlrev_b32 v1, 2, v0
  v_mov_b32 v2, 0
  v_writelane_b32 v2, 1, 0
  v_mov_b32 v8, 0
  s_mov_b32 s34, 0
Lw_182:
  ds_read_b32 v9, v8 offset:16
  s_waitcnt lgkmcnt(0)
  v_readfirstlane_b32 s35, v9
  s_nop 0
  s_cmp_ge_u32 s35, 1
  s_nop 1
  s_cbranch_scc1 Lwe_183
  s_sleep 2
  s_add_u32 s34, s34, 1
  s_cmp_lt_u32 s34, 800000
  s_cbranch_scc1 Lw_182
Lwe_183:
  s_mul_i32 s18, s32, 0x9E3779B1
  v_mov_b32 v11, s18
  s_mov_b32 s82, 0x0c0c0400
  s_mov_b32 s83, 0x04000c0c
  s_mov_b32 s65, 0xffffff00
  s_mov_b64 s[66:67], -1
  s_mov_b64 s[74:75], 0
  s_mov_b64 s[68:69], -1
  s_mov_b64 s[76:77], 0
  s_mov_b64 s[70:71], -1
  s_mov_b64 s[78:79], 0
  s_mov_b64 s[72:73], -1
  s_mov_b64 s[80:81], 0
  s_mov_b32 s34, 0
  s_mov_b32 s64, 4
L_w_loop:
  s_mov_b64 exec, s[66:67]
  global_load_dwordx4 v[24:27], v3, s[20:21] sc1
  s_mov_b64 exec, s[68:69]
  global_load_dwordx4 v[28:31], v3, s[22:23] sc1
  s_mov_b64 exec, s[70:71]
  global_load_dwordx4 v[32:35], v3, s[24:25] sc1
  s_mov_b64 exec, s[72:73]
  global_load_dwordx4 v[36:39], v3, s[26:27] sc1
  s_mov_b64 exec, -1
  s_waitcnt vmcnt(3)
  v_perm_b32 v8, v25, v24, s82
  v_perm_b32 v9, v27, v26, s83
  v_or_b32 v8, v8, v9
  v_cmp_ne_u32 vcc, v8, v11
  s_nop 0
  s_or_b64 vcc, vcc, s[74:75]
  s_cbranch_scc0 L_w_p0
L_w_c0:
  s_waitcnt vmcnt(2)
  v_perm_b32 v8, v29, v28, s82
  v_perm_b32 v9, v31, v30, s83
  v_or_b32 v8, v8, v9
  v_cmp_ne_u32 vcc, v8, v11
  s_nop 0
  s_or_b64 vcc, vcc, s[76:77]
  s_cbranch_scc0 L_w_p1
L_w_c1:
  s_waitcnt vmcnt(1)
  v_perm_b32 v8, v33, v32, s82
  v_perm_b32 v9, v35, v34, s83
  v_or_b32 v8, v8, v9
  v_cmp_ne_u32 vcc, v8, v11
  s_nop 0
  s_or_b64 vcc, vcc, s[78:79]
  s_cbranch_scc0 L_w_p2
L_w_c2:
  s_waitcnt vmcnt(0)
  v_perm_b32 v8, v37, v36, s82
  v_perm_b32 v9, v39, v38, s83
  v_or_b32 v8, v8, v9
  v_cmp_ne_u32 vcc, v8, v11
  s_nop 0
  s_or_b64 vcc, vcc, s[80:81]
  s_cbranch_scc0 L_w_p3
L_w_c3:
  s_add_u32 s34, s34, 1
  s_cmp_lt_u32 s34, 200000
  s_cbranch_scc1 L_w_loop
  s_branch L_w_done
L_w_p0:
  v_and_b32 v24, s65, v24
  v_and_b32 v26, s65, v26
  v_and_b32 v25, s65, v25
  v_and_b32 v27, s65, v27
  s_mov_b64 s[66:67], 1
  v_permlane32_swap_b32 v24, v26
  v_permlane32_swap_b32 v25, v27
  v_add_f32 v9, v24, v26
  v_add_f32 v10, v25, v27
  s_mov_b64 s[74:75], -1
  s_sub_u32 s64, s64, 1
  v_permlane16_swap_b32 v9, v10
  v_add_f32 v9, v9, v10
  s_nop 1
  v_add_f32_dpp v9, v9, v9 row_ror:8 row_mask:0xf bank_mask:0xf
  v_cvt_pk_bf16_f32 v10, v9, v9
  s_nop 1
  v_and_b32_dpp v16, v10, v4 row_newbcast:0 row_mask:0xf bank_mask:0xf
  v_and_b32_dpp v17, v10, v5 row_newbcast:0 row_mask:0xf bank_mask:0xf
  v_and_b32_dpp v18, v10, v6 row_newbcast:0 row_mask:0xf bank_mask:0xf
  v_and_b32_dpp v19, v10, v7 row_newbcast:0 row_mask:0xf bank_mask:0xf
  v_and_b32_dpp v20, v10, v4 row_newbcast:1 row_mask:0xf bank_mask:0xf
  v_and_b32_dpp v21, v10, v5 row_newbcast:1 row_mask:0xf bank_mask:0xf
  v_and_b32_dpp v22, v10, v6 row_newbcast:1 row_mask:0xf bank_mask:0xf
  v_and_b32_dpp v23, v10, v7 row_newbcast:1 row_mask:0xf bank_mask:0xf
  v_mfma_f32_16x16x32_bf16 v[40:43], v[16:19], v[40:43], 0
  v_and_b32_dpp v16, v10, v4 row_newbcast:2 row_mask:0xf bank_mask:0xf
  v_and_b32_dpp v17, v10, v5 row_newbcast:2 row_mask:0xf bank_mask:0xf
  v_and_b32_dpp v18, v10, v6 row_newbcast:2 row_mask:0xf bank_mask:0xf
  v_and_b32_dpp v19, v10, v7 row_newbcast:2 row_mask:0xf bank_mask:0xf
  v_mfma_f32_16x16x32_bf16 v[40:43], v[20:23], v[44:47], v[40:43]
  v_and_b32_dpp v20, v10, v4 row_newbcast:3 row_mask:0xf bank_mask:0xf
  v_and_b32_dpp v21, v10, v5 row_newbcast:3 row_mask:0xf bank_mask:0xf
  v_and_b32_dpp v22, v10, v6 row_newbcast:3 row_mask:0xf bank_mask:0xf
  v_and_b32_dpp v23, v10, v7 row_newbcast:3 row_mask:0xf bank_mask:0xf
  v_mfma_f32_16x16x32_bf16 v[40:43], v[16:19], v[48:51], v[40:43]
  v_and_b32_dpp v16, v10, v4 row_newbcast:4 row_mask:0xf bank_mask:0xf
  v_and_b32_dpp v17, v10, v5 row_newbcast:4 row_mask:0xf bank_mask:0xf
  v_and_b32_dpp v18, v10, v6 row_newbcast:4 row_mask:0xf bank_mask:0xf
  v_and_b32_dpp v19, v10, v7 row_newbcast:4 row_mask:0xf bank_mask:0xf
  v_mfma_f32_16x16x32_bf16 v[40:43], v[20:23], v[52:55], v[40:43]
  v_and_b32_dpp v20, v10, v4 row_newbcast:5 row_mask:0xf bank_mask:0xf
  v_and_b32_dpp v21, v10, v5 row_newbcast:5 row_mask:0xf bank_mask:0xf
  v_and_b32_dpp v22, v10, v6 row_newbcast:5 row_mask:0xf bank_mask:0xf
  v_and_b32_dpp v23, v10, v7 row_newbcast:5 row_mask:0xf bank_mask:0xf
  v_mfma_f32_16x16x32_bf16 v[40:43], v[16:19], v[56:59], v[40:43]
  v_and_b32_dpp v16, v10, v4 row_newbcast:6 row_mask:0xf bank_mask:0xf
  v_and_b32_dpp v17, v10, v5 row_newbcast:6 row_mask:0xf bank_mask:0xf
  v_and_b32_dpp v18, v10, v6 row_newbcast:6 row_mask:0xf bank_mask:0xf
  v_and_b32_dpp v19, v10, v7 row_newbcast:6 row_mask:0xf bank_mask:0xf
  v_mfma_f32_16x16x32_bf16 v[40:43], v[20:23], v[60:63], v[40:43]
  v_and_b32_dpp v20, v10, v4 row_newbcast:7 row_mask:0xf bank_mask:0xf
  v_and_b32_dpp v21, v10, v5 row_newbcast:7 row_mask:0xf bank_mask:0xf
  v_and_b32_dpp v22, v10, v6 row_newbcast:7 row_mask:0xf bank_mask:0xf
  v_and_b32_dpp v23, v10, v7 row_newbcast:7 row_mask:0xf bank_mask:0xf
  v_mfma_f32_16x16x32_bf16 v[40:43], v[16:19], v[64:67], v[40:43]
  s_nop 0
  v_mfma_f32_16x16x32_bf16 v[40:43], v[20:23], v[68:71], v[40:43]
  s_cmp_lg_u32 s64, 0
  s_cbranch_scc1 L_w_c0
  s_branch L_w_done
L_w_p1:
  v_and_b32 v28, s65, v28
  v_and_b32 v30, s65, v30
  v_and_b32 v29, s65, v29
  v_and_b32 v31, s65, v31
  s_mov_b64 s[68:69], 1
  v_permlane32_swap_b32 v28, v30
  v_permlane32_swap_b32 v29, v31
  v_add_f32 v9, v28, v30
  v_add_f32 v10, v29, v31
  s_mov_b64 s[76:77], -1
  s_sub_u32 s64, s64, 1
  v_permlane16_swap_b32 v9, v10
  v_add_f32 v9, v9, v10
  s_nop 1
  v_add_f32_dpp v9, v9, v9 row_ror:8 row_mask:0xf bank_mask:0xf
  v_cvt_pk_bf16_f32 v10, v9, v9
  s_nop 1
  v_and_b32_dpp v16, v10, v4 row_newbcast:0 row_mask:0xf bank_mask:0xf
  v_and_b32_dpp v17, v10, v5 row_newbcast:0 row_mask:0xf bank_mask:0xf
  v_and_b32_dpp v18, v10, v6 row_newbcast:0 row_mask:0xf bank_mask:0xf
  v_and_b32_dpp v19, v10, v7 row_newbcast:0 row_mask:0xf bank_mask:0xf
  v_and_b32_dpp v20, v10, v4 row_newbcast:1 row_mask:0xf bank_mask:0xf
  v_and_b32_dpp v21, v10, v5 row_newbcast:1 row_mask:0xf bank_mask:0xf
  v_and_b32_dpp v22, v10, v6 row_newbcast:1 row_mask:0xf bank_mask:0xf
  v_and_b32_dpp v23, v10, v7 row_newbcast:1 row_mask:0xf bank_mask:0xf
  v_mfma_f32_16x16x32_bf16 v[72:75], v[16:19], v[72:75], 0
  v_and_b32_dpp v16, v10, v4 row_newbcast:2 row_mask:0xf bank_mask:0xf
  v_and_b32_dpp v17, v10, v5 row_newbcast:2 row_mask:0xf bank_mask:0xf
  v_and_b32_dpp v18, v10, v6 row_newbcast:2 row_mask:0xf bank_mask:0xf
  v_and_b32_dpp v19, v10, v7 row_newbcast:2 row_mask:0xf bank_mask:0xf
  v_mfma_f32_16x16x32_bf16 v[72:75], v[20:23], v[76:79], v[72:75]
  v_and_b32_dpp v20, v10, v4 row_newbcast:3 row_mask:0xf bank_mask:0xf
  v_and_b32_dpp v21, v10, v5 row_newbcast:3 row_mask:0xf bank_mask:0xf
  v_and_b32_dpp v22, v10, v6 row_newbcast:3 row_mask:0xf bank_mask:0xf
  v_and_b32_dpp v23, v10, v7 row_newbcast:3 row_mask:0xf bank_mask:0xf
  v_mfma_f32_16x16x32_bf16 v[72:75], v[16:19], v[80:83], v[72:75]
  v_and_b32_dpp v16, v10, v4 row_newbcast:4 row_mask:0xf bank_mask:0xf
  v_and_b32_dpp v17, v10, v5 row_newbcast:4 row_mask:0xf bank_mask:0xf
  v_and_b32_dpp v18, v10, v6 row_newbcast:4 row_mask:0xf bank_mask:0xf
  v_and_b32_dpp v19, v10, v7 row_newbcast:4 row_mask:0xf bank_mask:0xf
  v_mfma_f32_16x16x32_bf16 v[72:75], v[20:23], v[84:87], v[72:75]
  v_and_b32_dpp v20, v10, v4 row_newbcast:5 row_mask:0xf bank_mask:0xf
  v_and_b32_dpp v21, v10, v5 row_newbcast:5 row_mask:0xf bank_mask:0xf
  v_and_b32_dpp v22, v10, v6 row_newbcast:5 row_mask:0xf bank_mask:0xf
  v_and_b32_dpp v23, v10, v7 row_newbcast:5 row_mask:0xf bank_mask:0xf
  v_mfma_f32_16x16x32_bf16 v[72:75], v[16:19], v[88:91], v[72:75]
  v_and_b32_dpp v16, v10, v4 row_newbcast:6 row_mask:0xf bank_mask:0xf
  v_and_b32_dpp v17, v10, v5 row_newbcast:6 row_mask:0xf bank_mask:0xf
  v_and_b32_dpp v18, v10, v6 row_newbcast:6 row_mask:0xf bank_mask:0xf
  v_and_b32_dpp v19, v10, v7 row_newbcast:6 row_mask:0xf bank_mask:0xf
  v_mfma_f32_16x16x32_bf16 v[72:75], v[20:23], v[92:95], v[72:75]
  v_and_b32_dpp v20, v10, v4 row_newbcast:7 row_mask:0xf bank_mask:0xf
  v_and_b32_dpp v21, v10, v5 row_newbcast:7 row_mask:0xf bank_mask:0xf
  v_and_b32_dpp v22, v10, v6 row_newbcast:7 row_mask:0xf bank_mask:0xf
  v_and_b32_dpp v23, v10, v7 row_newbcast:7 row_mask:0xf bank_mask:0xf
  v_mfma_f32_16x16x32_bf16 v[72:75], v[16:19], v[96:99], v[72:75]
  s_nop 0
  v_mfma_f32_16x16x32_bf16 v[72:75], v[20:23], v[100:103], v[72:75]
  s_cmp_lg_u32 s64, 0
  s_cbranch_scc1 L_w_c1
  s_branch L_w_done
L_w_p2:
  v_and_b32 v32, s65, v32
  v_and_b32 v34, s65, v34
  v_and_b32 v33, s65, v33
  v_and_b32 v35, s65, v35
  s_mov_b64 s[70:71], 1
  v_permlane32_swap_b32 v32, v34
  v_permlane32_swap_b32 v33, v35
  v_add_f32 v9, v32, v34
  v_add_f32 v10, v33, v35
  s_mov_b64 s[78:79], -1
  s_sub_u32 s64, s64, 1
  v_permlane16_swap_b32 v9, v10
  v_add_f32 v9, v9, v10
  s_nop 1
  v_add_f32_dpp v9, v9, v9 row_ror:8 row_mask:0xf bank_mask:0xf
  v_cvt_pk_bf16_f32 v10, v9, v9
  s_nop 1
  v_and_b32_dpp v16, v10, v4 row_newbcast:0 row_mask:0xf bank_mask:0xf
  v_and_b32_dpp v17, v10, v5 row_newbcast:0 row_mask:0xf bank_mask:0xf
  v_and_b32_dpp v18, v10, v6 row_newbcast:0 row_mask:0xf bank_mask:0xf
  v_and_b32_dpp v19, v10, v7 row_newbcast:0 row_mask:0xf bank_mask:0xf
  v_and_b32_dpp v20, v10, v4 row_newbcast:1 row_mask:0xf bank_mask:0xf
  v_and_b32_dpp v21, v10, v5 row_newbcast:1 row_mask:0xf bank_mask:0xf
  v_and_b32_dpp v22, v10, v6 row_newbcast:1 row_mask:0xf bank_mask:0xf
  v_and_b32_dpp v23, v10, v7 row_newbcast:1 row_mask:0xf bank_mask:0xf
  v_mfma_f32_16x16x32_bf16 v[104:107], v[16:19], v[104:107], 0
  v_and_b32_dpp v16, v10, v4 row_newbcast:2 row_mask:0xf bank_mask:0xf
  v_and_b32_dpp v17, v10, v5 row_newbcast:2 row_mask:0xf bank_mask:0xf
  v_and_b32_dpp v18, v10, v6 row_newbcast:2 row_mask:0xf bank_mask:0xf
  v_and_b32_dpp v19, v10, v7 row_newbcast:2 row_mask:0xf bank_mask:0xf
  v_mfma_f32_16x16x32_bf16 v[104:107], v[20:23], v[108:111], v[104:107]
  v_and_b32_dpp v20, v10, v4 row_newbcast:3 row_mask:0xf bank_mask:0xf
  v_and_b32_dpp v21, v10, v5 row_newbcast:3 row_mask:0xf bank_mask:0xf
  v_and_b32_dpp v22, v10, v6 row_newbcast:3 row_mask:0xf bank_mask:0xf
  v_and_b32_dpp v23, v10, v7 row_newbcast:3 row_mask:0xf bank_mask:0xf
  v_mfma_f32_16x16x32_bf16 v[104:107], v[16:19], v[112:115], v[104:107]
  v_and_b32_dpp v16, v10, v4 row_newbcast:4 row_mask:0xf bank_mask:0xf
  v_and_b32_dpp v17, v10, v5 row_newbcast:4 row_mask:0xf bank_mask:0xf
  v_and_b32_dpp v18, v10, v6 row_newbcast:4 row_mask:0xf bank_mask:0xf
  v_and_b32_dpp v19, v10, v7 row_newbcast:4 row_mask:0xf bank_mask:0xf
  v_mfma_f32_16x16x32_bf16 v[104:107], v[20:23], v[116:119], v[104:107]
  v_and_b32_dpp v20, v10, v4 row_newbcast:5 row_mask:0xf bank_mask:0xf
  v_and_b32_dpp v21, v10, v5 row_newbcast:5 row_mask:0xf bank_mask:0xf
  v_and_b32_dpp v22, v10, v6 row_newbcast:5 row_mask:0xf bank_mask:0xf
  v_and_b32_dpp v23, v10, v7 row_newbcast:5 row_mask:0xf bank_mask:0xf
  v_mfma_f32_16x16x32_bf16 v[104:107], v[16:19], v[120:123], v[104:107]
  v_and_b32_dpp v16, v10, v4 row_newbcast:6 row_mask:0xf bank_mask:0xf
  v_and_b32_dpp v17, v10, v5 row_newbcast:6 row_mask:0xf bank_mask:0xf
  v_and_b32_dpp v18, v10, v6 row_newbcast:6 row_mask:0xf bank_mask:0xf
  v_and_b32_dpp v19, v10, v7 row_newbcast:6 row_mask:0xf bank_mask:0xf
  v_mfma_f32_16x16x32_bf16 v[104:107], v[20:23], v[124:127], v[104:107]
  v_and_b32_dpp v20, v10, v4 row_newbcast:7 row_mask:0xf bank_mask:0xf
  v_and_b32_dpp v21, v10, v5 row_newbcast:7 row_mask:0xf bank_mask:0xf
  v_and_b32_dpp v22, v10, v6 row_newbcast:7 row_mask:0xf bank_mask:0xf
  v_and_b32_dpp v23, v10, v7 row_newbcast:7 row_mask:0xf bank_mask:0xf
  v_mfma_f32_16x16x32_bf16 v[104:107], v[16:19], v[128:131], v[104:107]
  s_nop 0
  v_mfma_f32_16x16x32_bf16 v[104:107], v[20:23], v[132:135], v[104:107]
  s_cmp_lg_u32 s64, 0
  s_cbranch_scc1 L_w_c2
  s_branch L_w_done
L_w_p3:
  v_and_b32 v36, s65, v36
  v_and_b32 v38, s65, v38
  v_and_b32 v37, s65, v37
  v_and_b32 v39, s65, v39
  s_mov_b64 s[72:73], 1
  v_permlane32_swap_b32 v36, v38
  v_permlane32_swap_b32 v37, v39
  v_add_f32 v9, v36, v38
  v_add_f32 v10, v37, v39
  s_mov_b64 s[80:81], -1
  s_sub_u32 s64, s64, 1
  v_permlane16_swap_b32 v9, v10
  v_add_f32 v9, v9, v10
  s_nop 1
  v_add_f32_dpp v9, v9, v9 row_ror:8 row_mask:0xf bank_mask:0xf
  v_cvt_pk_bf16_f32 v10, v9, v9
  s_nop 1
  v_and_b32_dpp v16, v10, v4 row_newbcast:0 row_mask:0xf bank_mask:0xf
  v_and_b32_dpp v17, v10, v5 row_newbcast:0 row_mask:0xf bank_mask:0xf
  v_and_b32_dpp v18, v10, v6 row_newbcast:0 row_mask:0xf bank_mask:0xf
  v_and_b32_dpp v19, v10, v7 row_newbcast:0 row_mask:0xf bank_mask:0xf
  v_and_b32_dpp v20, v10, v4 row_newbcast:1 row_mask:0xf bank_mask:0xf
  v_and_b32_dpp v21, v10, v5 row_newbcast:1 row_mask:0xf bank_mask:0xf
  v_and_b32_dpp v22, v10, v6 row_newbcast:1 row_mask:0xf bank_mask:0xf
  v_and_b32_dpp v23, v10, v7 row_newbcast:1 row_mask:0xf bank_mask:0xf
  v_mfma_f32_16x16x32_bf16 v[136:139], v[16:19], v[136:139], 0
  v_and_b32_dpp v16, v10, v4 row_newbcast:2 row_mask:0xf bank_mask:0xf
  v_and_b32_dpp v17, v10, v5 row_newbcast:2 row_mask:0xf bank_mask:0xf
  v_and_b32_dpp v18, v10, v6 row_newbcast:2 row_mask:0xf bank_mask:0xf
  v_and_b32_dpp v19, v10, v7 row_newbcast:2 row_mask:0xf bank_mask:0xf
  v_mfma_f32_16x16x32_bf16 v[136:139], v[20:23], v[140:143], v[136:139]
  v_and_b32_dpp v20, v10, v4 row_newbcast:3 row_mask:0xf bank_mask:0xf
  v_and_b32_dpp v21, v10, v5 row_newbcast:3 row_mask:0xf bank_mask:0xf
  v_and_b32_dpp v22, v10, v6 row_newbcast:3 row_mask:0xf bank_mask:0xf
  v_and_b32_dpp v23, v10, v7 row_newbcast:3 row_mask:0xf bank_mask:0xf
  v_mfma_f32_16x16x32_bf16 v[136:139], v[16:19], v[144:147], v[136:139]
  v_and_b32_dpp v16, v10, v4 row_newbcast:4 row_mask:0xf bank_mask:0xf
  v_and_b32_dpp v17, v10, v5 row_newbcast:4 row_mask:0xf bank_mask:0xf
  v_and_b32_dpp v18, v10, v6 row_newbcast:4 row_mask:0xf bank_mask:0xf
  v_and_b32_dpp v19, v10, v7 row_newbcast:4 row_mask:0xf bank_mask:0xf
  v_mfma_f32_16x16x32_bf16 v[136:139], v[20:23], v[148:151], v[136:139]
  v_and_b32_dpp v20, v10, v4 row_newbcast:5 row_mask:0xf bank_mask:0xf
  v_and_b32_dpp v21, v10, v5 row_newbcast:5 row_mask:0xf bank_mask:0xf
  v_and_b32_dpp v22, v10, v6 row_newbcast:5 row_mask:0xf bank_mask:0xf
  v_and_b32_dpp v23, v10, v7 row_newbcast:5 row_mask:0xf bank_mask:0xf
  v_mfma_f32_16x16x32_bf16 v[136:139], v[16:19], v[152:155], v[136:139]
  v_and_b32_dpp v16, v10, v4 row_newbcast:6 row_mask:0xf bank_mask:0xf
  v_and_b32_dpp v17, v10, v5 row_newbcast:6 row_mask:0xf bank_mask:0xf
  v_and_b32_dpp v18, v10, v6 row_newbcast:6 row_mask:0xf bank_mask:0xf
  v_and_b32_dpp v19, v10, v7 row_newbcast:6 row_mask:0xf bank_mask:0xf
  v_mfma_f32_16x16x32_bf16 v[136:139], v[20:23], v[156:159], v[136:139]
  v_and_b32_dpp v20, v10, v4 row_newbcast:7 row_mask:0xf bank_mask:0xf
  v_and_b32_dpp v21, v10, v5 row_newbcast:7 row_mask:0xf bank_mask:0xf
  v_and_b32_dpp v22, v10, v6 row_newbcast:7 row_mask:0xf bank_mask:0xf
  v_and_b32_dpp v23, v10, v7 row_newbcast:7 row_mask:0xf bank_mask:0xf
  v_mfma_f32_16x16x32_bf16 v[136:139], v[16:19], v[160:163], v[136:139]
  s_nop 0
  v_mfma_f32_16x16x32_bf16 v[136:139], v[20:23], v[164:167], v[136:139]
  s_cmp_lg_u32 s64, 0
  s_cbranch_scc1 L_w_c3
L_w_done:
  s_nop 5
  v_pk_add_f32 v[40:41], v[40:41], v[72:73]
  v_pk_add_f32 v[104:105], v[104:105], v[136:137]
  v_pk_add_f32 v[42:43], v[42:43], v[74:75]
  v_pk_add_f32 v[106:107], v[106:107], v[138:139]
  v_pk_add_f32 v[40:41], v[40:41], v[104:105]
  v_pk_add_f32 v[42:43], v[42:43], v[106:107]
  s_mov_b32 exec_hi, 0
  ds_write_b128 v12, v[40:43] offset:4608
  s_mov_b32 exec_lo, 1
  ds_add_rtn_u32 v10, v1, v2 offset:40
  s_mov_b32 exec_lo, -1
  ds_read_b128 v[44:47], v13 offset:4608
  ds_read_b128 v[48:51], v13 offset:5120
  ds_read_b128 v[52:55], v13 offset:5632
  ds_read_b128 v[56:59], v13 offset:6144
  s_waitcnt lgkmcnt(4)
  v_readfirstlane_b32 s18, v10
  s_nop 0
  s_cmp_lg_u32 s18, 3
  s_cbranch_scc1 L_wend
  s_waitcnt lgkmcnt(0)
  v_pk_add_f32 v[44:45], v[44:45], v[48:49]
  v_pk_add_f32 v[52:53], v[52:53], v[56:57]
  v_pk_add_f32 v[46:47], v[46:47], v[50:51]
  v_pk_add_f32 v[54:55], v[54:55], v[58:59]
  v_pk_add_f32 v[44:45], v[44:45], v[52:53]
  v_pk_add_f32 v[46:47], v[46:47], v[54:55]
  v_min_u32 v44, -2, v44
  v_min_u32 v45, -2, v45
  v_min_u32 v46, -2, v46
  v_min_u32 v47, -2, v47
  global_store_dwordx4 v15, v[44:47], s[30:31] sc1
L_wend:
  s_endpgm
L_tail_g:
  v_and_b32 v8, 1, v0
  v_lshlrev_b32 v8, 4, v8
  v_mov_b32 v9, 0xffff
  v_lshlrev_b32 v9, v8, v9
  v_bfe_u32 v8, v0, 1, 1
  v_cmp_eq_u32 vcc, 0, v8
  s_nop 1
  v_cndmask_b32 v4, 0, v9, vcc
  v_cmp_eq_u32 vcc, 1, v8
  s_nop 1
  v_cndmask_b32 v5, 0, v9, vcc
  v_mul_u32_u24 v3, 160, v2
  v_lshl_add_u32 v3, v1, 4, v3
  s_mul_i32 s18, s3, 640
  v_add_u32 v3, s18, v3
  s_add_u32 s20, s62, 331776
  s_addc_u32 s21, s63, 0
  s_add_u32 s22, s20, 5120
  s_addc_u32 s23, s21, 0
  s_mov_b32 s12, s36
  s_and_b32 s13, s37, 0xffff
  s_mov_b32 s14, 1280
  s_mov_b32 s15, 0x20000
  v_lshrrev_b32 v7, 1, v3
  buffer_load_dwordx2 v[10:11], v7, s[12:15], 0 offen
  s_mov_b32 exec_lo, 0x03ff03ff
  s_mov_b32 exec_hi, 0x03ff03ff
  s_mov_b32 s34, 0
Lp_184:
  global_load_dwordx4 v[120:123], v3, s[20:21] offset:0 sc1
  global_load_dwordx4 v[124:127], v3, s[20:21] offset:2560 sc1
  global_load_dwordx4 v[128:131], v3, s[22:23] offset:0 sc1
  global_load_dwordx4 v[132:135], v3, s[22:23] offset:2560 sc1
Lpf_186:
  s_waitcnt vmcnt(0)
  v_max_u32 v8, v121, v123
  v_max3_u32 v8, v8, v125, v127
  v_max3_u32 v8, v8, v129, v131
  v_max3_u32 v8, v8, v133, v135
  v_min_u32 v9, v121, v123
  v_min3_u32 v9, v9, v125, v127
  v_min3_u32 v9, v9, v129, v131
  v_min3_u32 v9, v9, v133, v135
  v_xor_b32 v8, s32, v8
  v_xor_b32 v9, s32, v9
  v_or_b32 v8, v8, v9
  v_cmp_ne_u32 vcc, 0, v8
  s_nop 0
  s_cmp_eq_u64 vcc, 0
  s_nop 1
  s_cbranch_scc1 Lpe_185
  s_sleep 32
  s_add_u32 s34, s34, 1
  s_cmp_lt_u32 s34, 200000
  s_cbranch_scc1 Lp_184
Lpe_185:
  s_mov_b64 exec, -1
  s_mov_b32 s18, 0x05040100
  s_mov_b32 s19, 0x07060302
  v_perm_b32 v152, v126, v122, s18
  v_perm_b32 v153, v134, v130, s18
  v_perm_b32 v154, v124, v120, s19
  v_perm_b32 v155, v132, v128, s19
  v_mov_b64_dpp v[156:157], v[152:153] row_newbcast:0 row_mask:0xf bank_mask:0xd
  s_nop 1
  v_mov_b64_dpp v[156:157], v[154:155] row_newbcast:0 row_mask:0xf bank_mask:0x2
  v_mov_b64_dpp v[158:159], v[152:153] row_newbcast:1 row_mask:0xf bank_mask:0xd
  s_nop 1
  v_mov_b64_dpp v[158:159], v[154:155] row_newbcast:1 row_mask:0xf bank_mask:0x2
  s_nop 1
  v_mfma_f32_16x16x32_bf16 v[136:139], v[156:159], v[40:43], 0
  v_mfma_f32_16x16x32_bf16 v[140:143], v[156:159], v[44:47], 0
  v_mfma_f32_16x16x32_bf16 v[144:147], v[156:159], v[48:51], 0
  v_mfma_f32_16x16x32_bf16 v[148:151], v[156:159], v[52:55], 0
  v_mov_b64_dpp v[160:161], v[152:153] row_newbcast:2 row_mask:0xf bank_mask:0xd
  s_nop 1
  v_mov_b64_dpp v[160:161], v[154:155] row_newbcast:2 row_mask:0xf bank_mask:0x2
  v_mov_b64_dpp v[162:163], v[152:153] row_newbcast:3 row_mask:0xf bank_mask:0xd
  s_nop 1
  v_mov_b64_dpp v[162:163], v[154:155] row_newbcast:3 row_mask:0xf bank_mask:0x2
  s_nop 1
  v_mfma_f32_16x16x32_bf16 v[136:139], v[160:163], v[56:59], v[136:139]
  v_mfma_f32_16x16x32_bf16 v[140:143], v[160:163], v[60:63], v[140:143]
  v_mfma_f32_16x16x32_bf16 v[144:147], v[160:163], v[64:67], v[144:147]
  v_mfma_f32_16x16x32_bf16 v[148:151], v[160:163], v[68:71], v[148:151]
  v_mov_b64_dpp v[156:157], v[152:153] row_newbcast:4 row_mask:0xf bank_mask:0xd
  s_nop 1
  v_mov_b64_dpp v[156:157], v[154:155] row_newbcast:4 row_mask:0xf bank_mask:0x2
  v_mov_b64_dpp v[158:159], v[152:153] row_newbcast:5 row_mask:0xf bank_mask:0xd
  s_nop 1
  v_mov_b64_dpp v[158:159], v[154:155] row_newbcast:5 row_mask:0xf bank_mask:0x2
  s_nop 1
  v_mfma_f32_16x16x32_bf16 v[136:139], v[156:159], v[72:75], v[136:139]
  v_mfma_f32_16x16x32_bf16 v[140:143], v[156:159], v[76:79], v[140:143]
  v_mfma_f32_16x16x32_bf16 v[144:147], v[156:159], v[80:83], v[144:147]
  v_mfma_f32_16x16x32_bf16 v[148:151], v[156:159], v[84:87], v[148:151]
  v_mov_b64_dpp v[160:161], v[152:153] row_newbcast:6 row_mask:0xf bank_mask:0xd
  s_nop 1
  v_mov_b64_dpp v[160:161], v[154:155] row_newbcast:6 row_mask:0xf bank_mask:0x2
  v_mov_b64_dpp v[162:163], v[152:153] row_newbcast:7 row_mask:0xf bank_mask:0xd
  s_nop 1
  v_mov_b64_dpp v[162:163], v[154:155] row_newbcast:7 row_mask:0xf bank_mask:0x2
  s_nop 1
  v_mfma_f32_16x16x32_bf16 v[136:139], v[160:163], v[88:91], v[136:139]
  v_mfma_f32_16x16x32_bf16 v[140:143], v[160:163], v[92:95], v[140:143]
  v_mfma_f32_16x16x32_bf16 v[144:147], v[160:163], v[96:99], v[144:147]
  v_mfma_f32_16x16x32_bf16 v[148:151], v[160:163], v[100:103], v[148:151]
  v_lshlrev_b32 v24, 16, v120
  v_lshlrev_b32 v32, 16, v122
  v_lshlrev_b32 v25, 16, v124
  v_lshlrev_b32 v33, 16, v126
  v_lshlrev_b32 v26, 16, v128
  v_lshlrev_b32 v34, 16, v130
  v_lshlrev_b32 v27, 16, v132
  v_lshlrev_b32 v35, 16, v134
  v_lshlrev_b32 v36, 16, v10
  v_and_b32 v37, 0xffff0000, v10
  v_lshlrev_b32 v38, 16, v11
  v_and_b32 v39, 0xffff0000, v11
  s_add_u32 s20, s62, 1310720
  s_addc_u32 s21, s63, 0
  s_add_u32 s22, s20, 16384
  s_addc_u32 s23, s21, 0
  s_add_u32 s24, s22, 16384
  s_addc_u32 s25, s23, 0
  s_add_u32 s26, s24, 16384
  s_addc_u32 s27, s25, 0
  s_add_u32 s66, s62, 1376256
  s_addc_u32 s67, s63, 0
  s_add_u32 s68, s66, 16384
  s_addc_u32 s69, s67, 0
  s_add_u32 s70, s68, 16384
  s_addc_u32 s71, s69, 0
  s_add_u32 s72, s70, 16384
  s_addc_u32 s73, s71, 0
  s_lshl_b32 s18, s3, 15
  s_lshl_b32 s19, s28, 7
  s_add_u32 s18, s18, s19
  s_add_u32 s74, s18, 1437696
  s_add_u32 s74, s62, s74
  s_addc_u32 s75, s63, 0
  s_add_u32 s76, s74, 131072
  s_addc_u32 s77, s75, 0
  s_add_u32 s78, s76, 131072
  s_addc_u32 s79, s77, 0
  v_add_u32 v3, v3, v15
  v_lshrrev_b32 v6, 3, v1
  v_lshl_add_u32 v15, v6, 14, v15
  v_and_b32 v6, 7, v1
  v_lshl_add_u32 v15, v6, 4, v15
  v_bfe_u32 v12, v0, 1, 4
  v_lshlrev_b32 v12, 4, v12
  v_lshrrev_b32 v13, 5, v0
  v_lshl_add_u32 v12, v13, 3, v12
  v_and_b32 v13, 1, v0
  v_lshl_add_u32 v12, v13, 2, v12
  s_lshl_b32 s18, s3, 3
  v_mov_b32 v13, s18
  v_and_b32 v6, 3, v1
  v_lshlrev_b32 v6, 4, v6
  v_lshl_add_u32 v6, v2, 6, v6
  v_lshl_add_u32 v7, v0, 3, s29
  s_mul_i32 s18, s32, 0x9E3779B1
  v_mov_b32 v20, s18
  s_mov_b32 s80, 117835008
  s_mov_b32 s81, 117835009
  s_mov_b32 s82, 117835010
  s_mov_b32 s83, 117835011
  v_mov_b32 v8, 0
  s_mov_b32 s34, 0
Lw_187:
  ds_read_b32 v9, v8 offset:32
  s_waitcnt lgkmcnt(0)
  v_readfirstlane_b32 s35, v9
  s_nop 0
  s_cmp_ge_u32 s35, 65536
  s_nop 1
  s_cbranch_scc1 Lwe_188
  s_sleep 8
  s_add_u32 s34, s34, 1
  s_cmp_lt_u32 s34, 800000
  s_cbranch_scc1 Lw_187
Lwe_188:
  s_lshr_b32 s17, s35, 20
  s_lshl_b32 s17, s17, 3
  s_add_u32 s17, s17, 432
  v_mov_b32 v8, 0
  s_mov_b32 s34, 0
Lw_189:
  ds_read_b32 v9, v8 offset:0
  s_waitcnt lgkmcnt(0)
  v_readfirstlane_b32 s35, v9
  s_nop 0
  s_cmp_ge_u32 s35, s17
  s_nop 1
  s_cbranch_scc1 Lwe_190
  s_sleep 2
  s_add_u32 s34, s34, 1
  s_cmp_lt_u32 s34, 800000
  s_cbranch_scc1 Lw_189
Lwe_190:
  v_mov_b32 v16, s48
  v_mov_b32 v17, s49
  v_mov_b32 v18, s50
  v_mov_b32 v19, s51
  v_and_b32 v22, 4, v0
  v_cmp_eq_u32 vcc, 0, v22
  s_nop 1
  v_cndmask_b32 v16, v18, v16, vcc
  v_cndmask_b32 v17, v19, v17, vcc
  v_mul_u32_u24 v22, 138240, v2
  v_bfe_u32 v18, v0, 3, 1
  v_mul_u32_u24 v18, 3456, v18
  v_add_u32 v22, v22, v18
  v_and_b32 v18, 3, v0
  v_lshl_add_u32 v22, v18, 4, v22
  s_mul_i32 s18, s3, 552960
  s_lshl_b32 s19, s28, 6
  s_add_u32 s18, s18, s19
  s_add_u32 s18, s18, 110592
  v_add_u32 v22, s18, v22
  v_add_co_u32 v16, vcc, v16, v22
  s_nop 1
  v_addc_co_u32 v17, vcc, 0, v17, vcc
  global_load_dwordx4 v[104:107], v[16:17], off nt
  v_add_co_u32 v16, vcc, 6912, v16
  s_nop 1
  v_addc_co_u32 v17, vcc, 0, v17, vcc
  global_load_dwordx4 v[108:111], v[16:17], off nt
  v_add_co_u32 v16, vcc, 6912, v16
  s_nop 1
  v_addc_co_u32 v17, vcc, 0, v17, vcc
  global_load_dwordx4 v[112:115], v[16:17], off nt
  v_add_co_u32 v16, vcc, 6912, v16
  s_nop 1
  v_addc_co_u32 v17, vcc, 0, v17, vcc
  v_mov_b32 v8, 0
  s_mov_b32 s34, 0
Lw_191:
  ds_read_b32 v9, v8 offset:16
  s_waitcnt lgkmcnt(0)
  v_readfirstlane_b32 s35, v9
  s_nop 0
  s_cmp_ge_u32 s35, 9
  s_nop 1
  s_cbranch_scc1 Lwe_192
  s_sleep 1
  s_add_u32 s34, s34, 1
  s_cmp_lt_u32 s34, 800000
  s_cbranch_scc1 Lw_191
Lwe_192:
  global_load_dwordx4 v[116:119], v[16:17], off nt
  s_mov_b32 s8, s52
  s_and_b32 s9, s53, 0xffff
  s_mov_b32 s10, 2211840
  s_mov_b32 s11, 0x20000
  v_bfe_u32 v22, v0, 3, 2
  v_mul_u32_u24 v22, 10240, v22
  v_lshrrev_b32 v18, 5, v0
  v_mul_u32_u24 v18, 1280, v18
  v_add_u32 v22, v22, v18
  v_and_b32 v18, 7, v0
  v_lshl_add_u32 v22, v18, 4, v22
  s_mul_i32 s18, s28, 40960
  s_lshl_b32 s19, s3, 7
  s_add_u32 s18, s18, s19
  s_mov_b32 s19, s29
  s_mov_b32 m0, s19
  s_nop 0
  buffer_load_dwordx4 v22, s[8:11], s18 offen nt lds
  s_add_u32 s18, s18, 2560
  s_add_u32 s19, s19, 1024
  s_mov_b32 m0, s19
  s_nop 0
  buffer_load_dwordx4 v22, s[8:11], s18 offen nt lds
  s_add_u32 s18, s18, 2560
  s_add_u32 s19, s19, 1024
  s_mov_b32 m0, s19
  s_nop 0
  buffer_load_dwordx4 v22, s[8:11], s18 offen nt lds
  s_add_u32 s18, s18, 2560
  s_add_u32 s19, s19, 1024
  s_mov_b32 m0, s19
  s_nop 0
  buffer_load_dwordx4 v22, s[8:11], s18 offen nt lds
  s_add_u32 s18, s18, 4294960128
  s_add_u32 s19, s19, 1024
  s_mov_b32 m0, s19
  s_nop 0
  buffer_load_dwordx4 v22, s[8:11], s18 offen nt lds
  s_add_u32 s18, s18, 2560
  s_add_u32 s19, s19, 1024
  s_mov_b32 m0, s19
  s_nop 0
  buffer_load_dwordx4 v22, s[8:11], s18 offen nt lds
  s_add_u32 s18, s18, 2560
  s_add_u32 s19, s19, 1024
  s_mov_b32 m0, s19
  s_nop 0
  buffer_load_dwordx4 v22, s[8:11], s18 offen nt lds
  s_add_u32 s18, s18, 2560
  s_add_u32 s19, s19, 1024
  s_mov_b32 m0, s19
  s_nop 0
  buffer_load_dwordx4 v22, s[8:11], s18 offen nt lds
  s_add_u32 s18, s18, 4294960128
  s_add_u32 s19, s19, 1024
  s_cmp_ge_u32 s3, 2
  s_cbranch_scc1 L_g_dw
  s_mov_b32 m0, s19
  s_nop 0
  buffer_load_dwordx4 v22, s[8:11], s18 offen nt lds
  s_add_u32 s18, s18, 2560
  s_add_u32 s19, s19, 1024
  s_mov_b32 m0, s19
  s_nop 0
  buffer_load_dwordx4 v22, s[8:11], s18 offen nt lds
  s_add_u32 s18, s18, 2560
  s_add_u32 s19, s19, 1024
  s_mov_b32 m0, s19
  s_nop 0
  buffer_load_dwordx4 v22, s[8:11], s18 offen nt lds
  s_add_u32 s18, s18, 2560
  s_add_u32 s19, s19, 1024
  s_mov_b32 m0, s19
  s_nop 0
  buffer_load_dwordx4 v22, s[8:11], s18 offen nt lds
  s_add_u32 s18, s18, 4294960128
  s_add_u32 s19, s19, 1024
L_g_dw:
  s_mul_i32 s19, s3, 12288
  s_add_u32 s19, s19, 67584
  v_lshl_add_u32 v22, v0, 4, s19
  v_lshl_add_u32 v23, v2, 8, s19
  v_bfe_u32 v18, v0, 3, 1
  v_lshl_add_u32 v23, v18, 10, v23
  v_bfe_u32 v18, v0, 2, 1
  v_lshl_add_u32 v23, v18, 7, v23
  v_and_b32 v18, 3, v0
  v_lshl_add_u32 v23, v18, 3, v23
  s_waitcnt vmcnt(8)
  ds_write_b128 v22, v[104:107] offset:0
  ds_write_b128 v22, v[108:111] offset:1024
  ds_write_b128 v22, v[112:115] offset:2048
  ds_write_b128 v22, v[116:119] offset:3072
  ds_read_b64_tr_b16 v[104:105], v23 offset:0
  ds_read_b64_tr_b16 v[106:107], v23 offset:2048
  ds_read_b64_tr_b16 v[108:109], v23 offset:32
  ds_read_b64_tr_b16 v[110:111], v23 offset:2080
  ds_read_b64_tr_b16 v[112:113], v23 offset:64
  ds_read_b64_tr_b16 v[114:115], v23 offset:2112
  ds_read_b64_tr_b16 v[116:117], v23 offset:96
  ds_read_b64_tr_b16 v[118:119], v23 offset:2144
  s_waitcnt lgkmcnt(0)
  v_mov_b64_dpp v[156:157], v[152:153] row_newbcast:8 row_mask:0xf bank_mask:0xd
  s_nop 1
  v_mov_b64_dpp v[156:157], v[154:155] row_newbcast:8 row_mask:0xf bank_mask:0x2
  v_mov_b64_dpp v[158:159], v[152:153] row_newbcast:9 row_mask:0xf bank_mask:0xd
  s_nop 1
  v_mov_b64_dpp v[158:159], v[154:155] row_newbcast:9 row_mask:0xf bank_mask:0x2
  s_nop 1
  v_mfma_f32_16x16x32_bf16 v[136:139], v[156:159], v[104:107], v[136:139]
  v_mfma_f32_16x16x32_bf16 v[140:143], v[156:159], v[108:111], v[140:143]
  v_mfma_f32_16x16x32_bf16 v[144:147], v[156:159], v[112:115], v[144:147]
  v_mfma_f32_16x16x32_bf16 v[148:151], v[156:159], v[116:119], v[148:151]
  s_mov_b32 exec_lo, 0xffff0000
  s_mov_b32 exec_hi, 0
  s_nop 2
  ds_add_f32 v12, v136 offset:5760
  ds_add_f32 v12, v140 offset:5888
  ds_add_f32 v12, v144 offset:5768
  ds_add_f32 v12, v148 offset:5896
  s_mov_b64 exec, -1
  v_mov_b32 v21, v136
  s_nop 1
  v_permlane16_swap_b32 v21, v140
  s_nop 1
  v_mov_b32_dpp v21, v144 quad_perm:[0,1,2,3] row_mask:0x4 bank_mask:0xf
  s_nop 1
  v_mov_b32_dpp v21, v148 quad_perm:[0,1,2,3] row_mask:0x8 bank_mask:0xf
  ds_add_f32 v12, v21 offset:5632
  s_lshl_b32 s18, s3, 8
  v_add_u32 v12, s18, v12
  v_mov_b32 v8, 0
  v_mov_b32 v9, 0
  v_mov_b32 v10, 0
  v_mov_b32 v11, 0
  s_mov_b32 exec_lo, 0x03ff03ff
  s_mov_b32 exec_hi, 0x03ff03ff
  s_mov_b32 s34, 0
L_g_loop:
  global_load_dwordx4 v[120:123], v3, s[20:21] sc1
  global_load_dwordx4 v[124:127], v3, s[22:23] sc1
  global_load_dwordx4 v[128:131], v3, s[24:25] sc1
  global_load_dwordx4 v[132:135], v3, s[26:27] sc1
  global_load_dwordx4 v[136:139], v3, s[66:67] sc1
  global_load_dwordx4 v[140:143], v3, s[68:69] sc1
  global_load_dwordx4 v[144:147], v3, s[70:71] sc1
  global_load_dwordx4 v[148:151], v3, s[72:73] sc1
  s_waitcnt vmcnt(0)
  v_pk_add_f32 v[152:153], v[120:121], v[124:125]
  v_pk_add_f32 v[156:157], v[128:129], v[132:133]
  v_pk_add_f32 v[160:161], v[136:137], v[140:141]
  v_pk_add_f32 v[164:165], v[144:145], v[148:149]
  v_pk_add_f32 v[154:155], v[122:123], v[126:127]
  v_pk_add_f32 v[158:159], v[130:131], v[134:135]
  v_pk_add_f32 v[162:163], v[138:139], v[142:143]
  v_pk_add_f32 v[166:167], v[146:147], v[150:151]
  v_pk_add_f32 v[152:153], v[152:153], v[156:157]
  v_pk_add_f32 v[160:161], v[160:161], v[164:165]
  v_pk_add_f32 v[154:155], v[154:155], v[158:159]
  v_pk_add_f32 v[162:163], v[162:163], v[166:167]
  v_pk_add_f32 v[152:153], v[152:153], v[160:161]
  v_pk_add_f32 v[154:155], v[154:155], v[162:163]
  v_cmp_u_f32 vcc, v152, v153
  v_cmp_u_f32 s[64:65], v154, v155
  s_nop 0
  s_or_b64 vcc, vcc, s[64:65]
  s_cbranch_scc0 L_g_got
  s_add_u32 s34, s34, 1
  s_cmp_lt_u32 s34, 256
  s_cbranch_scc1 L_g_loop
  s_waitcnt vmcnt(0)
  v_max_u32 v18, v120, v121
  v_max3_u32 v18, v18, v122, v123
  v_max3_u32 v18, v18, v124, v125
  v_max3_u32 v18, v18, v126, v127
  v_max3_u32 v18, v18, v128, v129
  v_max3_u32 v18, v18, v130, v131
  v_max3_u32 v18, v18, v132, v133
  v_max3_u32 v18, v18, v134, v135
  v_max3_u32 v18, v18, v136, v137
  v_max3_u32 v18, v18, v138, v139
  v_max3_u32 v18, v18, v140, v141
  v_max3_u32 v18, v18, v142, v143
  v_max3_u32 v18, v18, v144, v145
  v_max3_u32 v18, v18, v146, v147
  v_max3_u32 v18, v18, v148, v149
  v_max3_u32 v18, v18, v150, v151
  v_cmp_eq_u32 vcc, -1, v18
  s_nop 0
  s_cmp_eq_u64 vcc, 0
  s_nop 1
  s_cbranch_scc1 L_g_last
  s_cmp_lt_u32 s34, 200000
  s_cbranch_scc1 L_g_loop
L_g_last:
  v_add_f32 v152, v120, v124
  v_add_f32 v152, v152, v128
  v_add_f32 v152, v152, v132
  v_add_f32 v152, v152, v136
  v_add_f32 v152, v152, v140
  v_add_f32 v152, v152, v144
  v_add_f32 v152, v152, v148
  v_add_f32 v153, v121, v125
  v_add_f32 v153, v153, v129
  v_add_f32 v153, v153, v133
  v_add_f32 v153, v153, v137
  v_add_f32 v153, v153, v141
  v_add_f32 v153, v153, v145
  v_add_f32 v153, v153, v149
  v_add_f32 v154, v122, v126
  v_add_f32 v154, v154, v130
  v_add_f32 v154, v154, v134
  v_add_f32 v154, v154, v138
  v_add_f32 v154, v154, v142
  v_add_f32 v154, v154, v146
  v_add_f32 v154, v154, v150
  v_add_f32 v155, v123, v127
  v_add_f32 v155, v155, v131
  v_add_f32 v155, v155, v135
  v_add_f32 v155, v155, v139
  v_add_f32 v155, v155, v143
  v_add_f32 v155, v155, v147
  v_add_f32 v155, v155, v151
L_g_dry:
L_g_got:
  v_fma_f32 v152, v152, v24, v36
  v_fma_f32 v153, v153, v25, v37
  v_fma_f32 v154, v154, v26, v38
  v_fma_f32 v155, v155, v27, v39
  v_readfirstlane_b32 s18, v152
  s_nop 1
  v_subrev_f32 v8, s18, v152
  v_subrev_f32 v9, s18, v153
  v_subrev_f32 v10, s18, v154
  v_subrev_f32 v11, s18, v155
  v_mul_f32 v152, v8, v32
  v_mul_f32 v153, v9, v33
  v_mul_f32 v154, v10, v34
  v_mul_f32 v155, v11, v35
  v_cvt_pk_bf16_f32 v18, v152, v153
  v_cvt_pk_bf16_f32 v19, v154, v155
  s_mov_b64 exec, -1
  s_nop 0
  v_mov_b64_dpp v[156:157], v[18:19] row_newbcast:0 row_mask:0xf bank_mask:0xf
  v_mov_b64_dpp v[158:159], v[18:19] row_newbcast:1 row_mask:0xf bank_mask:0xf
  s_nop 1
  v_mfma_f32_16x16x32_bf16 v[24:27], v[156:159], v[40:43], 0
  v_mov_b64_dpp v[160:161], v[18:19] row_newbcast:2 row_mask:0xf bank_mask:0xf
  v_mov_b64_dpp v[162:163], v[18:19] row_newbcast:3 row_mask:0xf bank_mask:0xf
  v_mfma_f32_16x16x32_bf16 v[28:31], v[156:159], v[44:47], 0
  v_add_f32 v16, v8, v9
  v_mul_f32 v17, v8, v8
  v_mfma_f32_16x16x32_bf16 v[32:35], v[156:159], v[48:51], 0
  v_add_f32 v22, v10, v11
  v_fmac_f32 v17, v9, v9
  v_mfma_f32_16x16x32_bf16 v[36:39], v[156:159], v[52:55], 0
  v_add_f32 v16, v16, v22
  v_fmac_f32 v17, v10, v10
  v_mfma_f32_16x16x32_bf16 v[24:27], v[160:163], v[56:59], v[24:27]
  v_mov_b64_dpp v[156:157], v[18:19] row_newbcast:4 row_mask:0xf bank_mask:0xf
  v_mov_b64_dpp v[158:159], v[18:19] row_newbcast:5 row_mask:0xf bank_mask:0xf
  ds_read2st64_b64 v[120:123], v7 offset0:0 offset1:1
  v_mfma_f32_16x16x32_bf16 v[28:31], v[160:163], v[60:63], v[28:31]
  v_fmac_f32 v17, v11, v11
  ds_read2st64_b64 v[124:127], v7 offset0:2 offset1:3
  v_mfma_f32_16x16x32_bf16 v[32:35], v[160:163], v[64:67], v[32:35]
  v_add_f32_dpp v16, v16, v16 quad_perm:[1,0,3,2] row_mask:0xf bank_mask:0xf
  v_add_f32_dpp v17, v17, v17 quad_perm:[1,0,3,2] row_mask:0xf bank_mask:0xf
  ds_read2st64_b64 v[128:131], v7 offset0:4 offset1:5
  v_mfma_f32_16x16x32_bf16 v[36:39], v[160:163], v[68:71], v[36:39]
  v_add_f32_dpp v16, v16, v16 quad_perm:[2,3,0,1] row_mask:0xf bank_mask:0xf
  v_add_f32_dpp v17, v17, v17 quad_perm:[2,3,0,1] row_mask:0xf bank_mask:0xf
  ds_read2st64_b64 v[132:135], v7 offset0:6 offset1:7
  v_mfma_f32_16x16x32_bf16 v[24:27], v[156:159], v[72:75], v[24:27]
  v_mov_b64_dpp v[160:161], v[18:19] row_newbcast:6 row_mask:0xf bank_mask:0xf
  v_mov_b64_dpp v[162:163], v[18:19] row_newbcast:7 row_mask:0xf bank_mask:0xf
  ds_read2st64_b64 v[136:139], v7 offset0:8 offset1:9
  v_mfma_f32_16x16x32_bf16 v[28:31], v[156:159], v[76:79], v[28:31]
  v_add_f32_dpp v16, v16, v16 row_half_mirror row_mask:0xf bank_mask:0xf
  v_add_f32_dpp v17, v17, v17 row_half_mirror row_mask:0xf bank_mask:0xf
  ds_read2st64_b64 v[140:143], v7 offset0:10 offset1:11
  v_mfma_f32_16x16x32_bf16 v[32:35], v[156:159], v[80:83], v[32:35]
  v_add_f32_dpp v16, v16, v16 row_mirror row_mask:0xf bank_mask:0xf
  v_add_f32_dpp v17, v17, v17 row_mirror row_mask:0xf bank_mask:0xf
  ds_read2st64_b64 v[144:147], v7 offset0:12 offset1:13
  v_mfma_f32_16x16x32_bf16 v[36:39], v[156:159], v[84:87], v[36:39]
  v_add_f32_dpp v16, v16, v16 row_bcast:15 row_mask:0xa bank_mask:0xf
  v_add_f32_dpp v17, v17, v17 row_bcast:15 row_mask:0xa bank_mask:0xf
  ds_read2st64_b64 v[148:151], v7 offset0:14 offset1:15
  v_mfma_f32_16x16x32_bf16 v[24:27], v[160:163], v[88:91], v[24:27]
  v_mov_b64_dpp v[156:157], v[18:19] row_newbcast:8 row_mask:0xf bank_mask:0xf
  v_mov_b64_dpp v[158:159], v[18:19] row_newbcast:9 row_mask:0xf bank_mask:0xf
  ds_read2st64_b64 v[40:43], v7 offset0:16 offset1:17
  v_mfma_f32_16x16x32_bf16 v[28:31], v[160:163], v[92:95], v[28:31]
  v_add_f32_dpp v16, v16, v16 row_bcast:31 row_mask:0xc bank_mask:0xf
  v_add_f32_dpp v17, v17, v17 row_bcast:31 row_mask:0xc bank_mask:0xf
  ds_read2st64_b64 v[44:47], v7 offset0:18 offset1:19
  v_mfma_f32_16x16x32_bf16 v[32:35], v[160:163], v[96:99], v[32:35]
  v_mul_f32 v22, 0x3bcccccd, v16
  ds_read2st64_b64 v[48:51], v7 offset0:20 offset1:21
  v_mfma_f32_16x16x32_bf16 v[36:39], v[160:163], v[100:103], v[36:39]
  v_fma_f32 v17, -v22, v16, v17
  v_add_f32 v16, s18, v22
  ds_read2st64_b64 v[52:55], v7 offset0:22 offset1:23
  v_mfma_f32_16x16x32_bf16 v[24:27], v[156:159], v[104:107], v[24:27]
  v_mfma_f32_16x16x32_bf16 v[28:31], v[156:159], v[108:111], v[28:31]
  v_mfma_f32_16x16x32_bf16 v[32:35], v[156:159], v[112:115], v[32:35]
  v_mfma_f32_16x16x32_bf16 v[36:39], v[156:159], v[116:119], v[36:39]
  s_mov_b32 exec_lo, 0
  s_mov_b32 exec_hi, 0x80000000
  ds_write_b64 v13, v[16:17] offset:6656
  s_mov_b64 exec, -1
  s_nop 1
  v_mov_b32_dpp v24, v28 quad_perm:[0,1,2,3] row_mask:0x2 bank_mask:0xf
  s_nop 1
  v_mov_b32_dpp v24, v32 quad_perm:[0,1,2,3] row_mask:0x4 bank_mask:0xf
  s_nop 1
  v_mov_b32_dpp v24, v36 quad_perm:[0,1,2,3] row_mask:0x8 bank_mask:0xf
  v_fmac_f32 v24, s18, v21
  ds_write_b32 v12, v24 offset:4608
  s_waitcnt lgkmcnt(0)
  s_barrier
  ds_read_b128 v[156:159], v14 offset:6656
  ds_read_b128 v[160:163], v14 offset:6672
  ds_read_b128 v[56:59], v6 offset:4608
  ds_read_b128 v[60:63], v6 offset:4864
  ds_read_b128 v[64:67], v6 offset:5120
  ds_read_b128 v[68:71], v6 offset:5376
  ds_read_b128 v[72:75], v6 offset:5632
  ds_read_b128 v[76:79], v6 offset:5888
  s_waitcnt lgkmcnt(6)
  v_pk_add_f32 v[8:9], v[156:157], v[158:159]
  v_pk_add_f32 v[10:11], v[160:161], v[162:163]
  v_pk_add_f32 v[8:9], v[8:9], v[10:11]
  v_mul_f32 v8, 0x3e800000, v8
  v_mul_f32 v9, 0x3bcccccd, v9
  v_sub_f32 v156, v156, v8
  v_sub_f32 v158, v158, v8
  v_sub_f32 v160, v160, v8
  v_sub_f32 v162, v162, v8
  v_fmac_f32 v9, v156, v156
  v_fmac_f32 v9, v158, v158
  v_fmac_f32 v9, v160, v160
  v_fmac_f32 v9, v162, v162
  v_max_f32 v9, 0, v9
  v_mul_f32 v10, 0x3e800000, v9
  v_cvt_pk_bf16_f32 v9, v8, v10
  v_lshlrev_b32 v8, 16, v9
  v_and_b32 v10, 0xffff0000, v9
  v_add_f32 v10, 925353388, v10
  v_cvt_pk_bf16_f32 v10, v10, v10
  v_and_b32 v10, 0xffff0000, v10
  v_sqrt_f32 v10, v10
  s_nop 0
  v_cvt_pk_bf16_f32 v10, v10, v10
  v_and_b32 v10, 0xffff0000, v10
  v_rcp_f32 v10, v10
  s_waitcnt lgkmcnt(0)
  v_pk_add_f32 v[56:57], v[56:57], v[60:61]
  v_pk_add_f32 v[64:65], v[64:65], v[68:69]
  v_pk_add_f32 v[58:59], v[58:59], v[62:63]
  v_pk_add_f32 v[66:67], v[66:67], v[70:71]
  v_fma_f32 v56, -v8, v72, v56
  v_fma_f32 v57, -v8, v73, v57
  v_fma_f32 v58, -v8, v74, v58
  v_fma_f32 v59, -v8, v75, v59
  v_pk_add_f32 v[56:57], v[56:57], v[64:65]
  v_pk_add_f32 v[58:59], v[58:59], v[66:67]
  v_fma_f32 v152, v56, v10, v76
  v_fma_f32 v153, v57, v10, v77
  v_fma_f32 v154, v58, v10, v78
  v_fma_f32 v155, v59, v10, v79
  v_mul_f32 v8, 0xbfb8aa3b, v152
  v_mul_f32 v9, 0xbfb8aa3b, v153
  v_exp_f32 v8, v8
  v_exp_f32 v9, v9
  v_mul_f32 v152, v152, v154
  v_mul_f32 v153, v153, v155
  v_add_f32 v8, 1.0, v8
  v_add_f32 v9, 1.0, v9
  v_rcp_f32 v8, v8
  v_rcp_f32 v9, v9
  v_mul_f32 v152, v152, v8
  v_mul_f32 v153, v153, v9
  v_cvt_pk_bf16_f32 v152, v152, v152
  v_cvt_pk_bf16_f32 v153, v153, v153
  s_nop 0
  v_and_b32_dpp v156, v152, v4 row_newbcast:0 row_mask:0xf bank_mask:0xf
  v_and_b32_dpp v157, v152, v5 row_newbcast:0 row_mask:0xf bank_mask:0xf
  v_and_b32_dpp v158, v153, v4 row_newbcast:0 row_mask:0xf bank_mask:0xf
  v_and_b32_dpp v159, v153, v5 row_newbcast:0 row_mask:0xf bank_mask:0xf
  v_and_b32_dpp v160, v152, v4 row_newbcast:1 row_mask:0xf bank_mask:0xf
  v_and_b32_dpp v161, v152, v5 row_newbcast:1 row_mask:0xf bank_mask:0xf
  v_and_b32_dpp v162, v153, v4 row_newbcast:1 row_mask:0xf bank_mask:0xf
  v_and_b32_dpp v163, v153, v5 row_newbcast:1 row_mask:0xf bank_mask:0xf
  v_mfma_f32_16x16x32_bf16 v[24:27], v[156:159], v[120:123], 0
  v_mfma_f32_16x16x32_bf16 v[28:31], v[156:159], v[136:139], 0
  v_mfma_f32_16x16x32_bf16 v[32:35], v[156:159], v[40:43], 0
  v_and_b32_dpp v156, v152, v4 row_newbcast:2 row_mask:0xf bank_mask:0xf
  v_and_b32_dpp v157, v152, v5 row_newbcast:2 row_mask:0xf bank_mask:0xf
  v_and_b32_dpp v158, v153, v4 row_newbcast:2 row_mask:0xf bank_mask:0xf
  v_and_b32_dpp v159, v153, v5 row_newbcast:2 row_mask:0xf bank_mask:0xf
  v_mfma_f32_16x16x32_bf16 v[24:27], v[160:163], v[124:127], v[24:27]
  v_mfma_f32_16x16x32_bf16 v[28:31], v[160:163], v[140:143], v[28:31]
  v_mfma_f32_16x16x32_bf16 v[32:35], v[160:163], v[44:47], v[32:35]
  v_and_b32_dpp v160, v152, v4 row_newbcast:3 row_mask:0xf bank_mask:0xf
  v_and_b32_dpp v161, v152, v5 row_newbcast:3 row_mask:0xf bank_mask:0xf
  v_and_b32_dpp v162, v153, v4 row_newbcast:3 row_mask:0xf bank_mask:0xf
  v_and_b32_dpp v163, v153, v5 row_newbcast:3 row_mask:0xf bank_mask:0xf
  v_mfma_f32_16x16x32_bf16 v[24:27], v[156:159], v[128:131], v[24:27]
  v_mfma_f32_16x16x32_bf16 v[28:31], v[156:159], v[144:147], v[28:31]
  v_mfma_f32_16x16x32_bf16 v[32:35], v[156:159], v[48:51], v[32:35]
  v_mfma_f32_16x16x32_bf16 v[24:27], v[160:163], v[132:135], v[24:27]
  v_mfma_f32_16x16x32_bf16 v[28:31], v[160:163], v[148:151], v[28:31]
  v_mfma_f32_16x16x32_bf16 v[32:35], v[160:163], v[52:55], v[32:35]
  s_mov_b64 exec, 0xffff
  s_nop 4
  v_perm_b32 v24, v24, v20, s80
  v_perm_b32 v25, v25, v20, s81
  v_perm_b32 v26, v26, v20, s82
  v_perm_b32 v27, v27, v20, s83
  global_store_dwordx4 v15, v[24:27], s[74:75] sc1
  v_perm_b32 v28, v28, v20, s80
  v_perm_b32 v29, v29, v20, s81
  v_perm_b32 v30, v30, v20, s82
  v_perm_b32 v31, v31, v20, s83
  global_store_dwordx4 v15, v[28:31], s[76:77] sc1
  s_cmp_ge_u32 s3, 2
  s_cbranch_scc1 L_g_end
  v_perm_b32 v32, v32, v20, s80
  v_perm_b32 v33, v33, v20, s81
  v_perm_b32 v34, v34, v20, s82
  v_perm_b32 v35, v35, v20, s83
  global_store_dwordx4 v15, v[32:35], s[78:79] sc1
L_g_end:
  s_endpgm
L_final:
  s_cmp_ge_u32 s28, 20
  s_cbranch_scc1 L_end
  v_mov_b32 v6, 0
  s_mov_b32 s34, 0
Lw_193:
  ds_read_b32 v7, v6 offset:8
  s_waitcnt lgkmcnt(0)
  v_readfirstlane_b32 s35, v7
  s_nop 0
  s_cmp_eq_u32 s35, 1
  s_nop 1
  s_cbranch_scc1 Lwe_194
  s_sleep 8
  s_add_u32 s34, s34, 1
  s_cmp_lt_u32 s34, 800000
  s_cbranch_scc1 Lw_193
Lwe_194:
  v_mov_b32 v14, 0
  s_mov_b32 s34, 0
Lw_195:
  ds_read_b32 v15, v14 offset:28
  s_waitcnt lgkmcnt(0)
  v_readfirstlane_b32 s35, v15
  s_nop 0
  s_cmp_ge_u32 s35, 1
  s_nop 1
  s_cbranch_scc1 Lwe_196
  s_sleep 8
  s_add_u32 s34, s34, 1
  s_cmp_lt_u32 s34, 800000
  s_cbranch_scc1 Lw_195
Lwe_196:
  s_lshl_b32 s29, s28, 7
  s_add_u32 s20, s29, 331776
  s_add_u32 s20, s62, s20
  s_addc_u32 s21, s63, 0
  v_and_b32 v4, 7, v1
  v_mul_u32_u24 v3, 2560, v2
  v_lshl_add_u32 v3, v4, 4, v3
  v_lshl_add_u32 v7, v4, 2, v2
  v_lshlrev_b32 v7, 1, v7
  s_lshl_b32 s30, s28, 6
  s_mov_b32 s12, s36
  s_and_b32 s13, s37, 0xffff
  s_mov_b32 s14, 1280
  s_mov_b32 s15, 0x20000
  buffer_load_ushort v10, v7, s[12:15], s30 offen
  s_mov_b32 s34, 0
Lp_197:
  global_load_dwordx4 v[40:43], v3, s[20:21] sc1
Lpf_199:
  s_waitcnt vmcnt(0)
  v_max_u32 v8, v41, v43
  v_min_u32 v9, v41, v43
  v_xor_b32 v8, s32, v8
  v_xor_b32 v9, s32, v9
  v_or_b32 v8, v8, v9
  v_cmp_ne_u32 vcc, 0, v8
  s_nop 0
  s_cmp_eq_u64 vcc, 0
  s_nop 1
  s_cbranch_scc1 Lpe_198
  s_sleep 32
  s_add_u32 s34, s34, 1
  s_cmp_lt_u32 s34, 200000
  s_cbranch_scc1 Lp_197
Lpe_198:
  v_lshlrev_b32 v24, 16, v40
  v_and_b32 v25, 0xffff0000, v42
  v_lshlrev_b32 v26, 16, v10
  v_bfrev_b32 v3, v0
  v_bfe_u32 v3, v3, 26, 3
  v_lshl_add_u32 v3, v3, 14, v15
  v_and_b32 v4, 7, v0
  v_lshl_add_u32 v3, v4, 4, v3
  s_add_u32 s20, s29, 1310720
  s_add_u32 s20, s62, s20
  s_addc_u32 s21, s63, 0
  s_lshl_b32 s18, s28, 14
  s_add_u32 s22, s18, 1441792
  s_add_u32 s22, s62, s22
  s_addc_u32 s23, s63, 0
  v_lshl_add_u32 v5, v0, 4, v15
  v_mov_b32 v64, 0
  v_mov_b32 v65, 0
  v_mov_b32 v66, 0
  v_mov_b32 v67, 0
  v_mov_b32 v8, 0
  s_mov_b32 s34, 0
Lw_200:
  ds_read_b32 v9, v8 offset:16
  s_waitcnt lgkmcnt(0)
  v_readfirstlane_b32 s35, v9
  s_nop 0
  s_cmp_ge_u32 s35, 8
  s_nop 1
  s_cbranch_scc1 Lwe_201
  s_sleep 2
  s_add_u32 s34, s34, 1
  s_cmp_lt_u32 s34, 800000
  s_cbranch_scc1 Lw_200
Lwe_201:
  s_mov_b32 s34, 0
Lp_202:
  global_load_dwordx4 v[40:43], v3, s[20:21] sc1
  s_waitcnt vmcnt(0)
  v_max_u32 v8, v40, v41
  v_max3_u32 v8, v8, v42, v43
  v_cmp_eq_u32 vcc, -1, v8
  s_nop 0
  s_cmp_eq_u64 vcc, 0
  s_cbranch_scc1 Lpe_203
  s_sleep 2
  s_add_u32 s34, s34, 1
  s_cmp_lt_u32 s34, 200000
  s_nop 0
  s_cbranch_scc1 Lp_202
Lpe_203:
  s_cmp_lg_u32 s28, 0
  s_cbranch_scc1 L_f_e
  s_add_u32 s24, s62, 327680
  s_addc_u32 s25, s63, 0
  v_lshlrev_b32 v8, 2, v0
  v_mov_b32 v9, s32
  s_mov_b32 exec_hi, 0
  global_store_dword v8, v9, s[24:25] sc1
  s_mov_b32 exec_hi, -1
L_f_e:
  v_permlane32_swap_b32 v40, v42
  v_permlane32_swap_b32 v41, v43
  v_add_f32 v9, v40, v42
  v_add_f32 v10, v41, v43
  s_nop 1
  v_permlane16_swap_b32 v9, v10
  v_add_f32 v9, v9, v10
  s_nop 1
  v_add_f32_dpp v9, v9, v9 row_ror:8 row_mask:0xf bank_mask:0xf
  v_cvt_pk_bf16_f32 v9, v9, v9
  v_and_b32 v9, 0xffff0000, v9
  v_mul_f32 v9, v9, v24
  v_cvt_pk_bf16_f32 v9, v9, v9
  v_and_b32 v9, 0xffff0000, v9
  v_add_f32 v26, v26, v9
  v_cvt_pk_bf16_f32 v26, v26, v26
  v_and_b32 v26, 0xffff0000, v26
  s_mov_b32 s12, s58
  s_and_b32 s13, s59, 0xffff
  s_mov_b32 s14, 1280
  s_mov_b32 s15, 0x20000
  s_mul_i32 s69, s32, 0x9E3779B1
  s_and_b32 s66, s69, 0xff
  s_bfe_u32 s67, s69, 0x80008
  s_bfe_u32 s68, s69, 0x80010
  s_lshr_b32 s69, s69, 24
  s_mov_b32 s34, 0
L_f_loop:
  global_load_dwordx4 v[40:43], v5, s[22:23] offset:-4096 sc1
  global_load_dwordx4 v[44:47], v5, s[22:23] offset:-3072 sc1
  global_load_dwordx4 v[48:51], v5, s[22:23] offset:-2048 sc1
  global_load_dwordx4 v[52:55], v5, s[22:23] offset:-1024 sc1
  global_load_dwordx4 v[56:59], v5, s[22:23] offset:0 sc1
  global_load_dwordx4 v[60:63], v5, s[22:23] offset:1024 sc1
  s_mov_b32 exec_hi, 0xffff
  global_load_dwordx4 v[64:67], v5, s[22:23] offset:2048 sc1
  s_mov_b32 exec_hi, -1
  s_waitcnt vmcnt(6)
  v_xor_b32 v40, s66, v40
  v_xor_b32 v41, s67, v41
  v_xor_b32 v42, s68, v42
  v_xor_b32 v43, s69, v43
  v_or3_b32 v8, v40, v41, v42
  v_or_b32 v8, v8, v43
  s_waitcnt vmcnt(5)
  v_xor_b32 v44, s66, v44
  v_xor_b32 v45, s67, v45
  v_xor_b32 v46, s68, v46
  v_xor_b32 v47, s69, v47
  v_or3_b32 v8, v8, v44, v45
  v_or3_b32 v8, v8, v46, v47
  v_pk_add_f32 v[28:29], v[40:41], v[44:45]
  v_pk_add_f32 v[30:31], v[42:43], v[46:47]
  s_waitcnt vmcnt(4)
  v_xor_b32 v48, s66, v48
  v_xor_b32 v49, s67, v49
  v_xor_b32 v50, s68, v50
  v_xor_b32 v51, s69, v51
  v_or3_b32 v8, v8, v48, v49
  v_or3_b32 v8, v8, v50, v51
  s_waitcnt vmcnt(3)
  v_xor_b32 v52, s66, v52
  v_xor_b32 v53, s67, v53
  v_xor_b32 v54, s68, v54
  v_xor_b32 v55, s69, v55
  v_or3_b32 v8, v8, v52, v53
  v_or3_b32 v8, v8, v54, v55
  v_pk_add_f32 v[32:33], v[48:49], v[52:53]
  v_pk_add_f32 v[34:35], v[50:51], v[54:55]
  v_pk_add_f32 v[28:29], v[28:29], v[32:33]
  v_pk_add_f32 v[30:31], v[30:31], v[34:35]
  s_waitcnt vmcnt(2)
  v_xor_b32 v56, s66, v56
  v_xor_b32 v57, s67, v57
  v_xor_b32 v58, s68, v58
  v_xor_b32 v59, s69, v59
  v_or3_b32 v8, v8, v56, v57
  v_or3_b32 v8, v8, v58, v59
  s_waitcnt vmcnt(1)
  v_xor_b32 v60, s66, v60
  v_xor_b32 v61, s67, v61
  v_xor_b32 v62, s68, v62
  v_xor_b32 v63, s69, v63
  v_or3_b32 v8, v8, v60, v61
  v_or3_b32 v8, v8, v62, v63
  v_pk_add_f32 v[36:37], v[56:57], v[60:61]
  v_pk_add_f32 v[38:39], v[58:59], v[62:63]
  s_waitcnt vmcnt(0)
  s_mov_b32 exec_hi, 0xffff
  v_xor_b32 v64, s66, v64
  v_xor_b32 v65, s67, v65
  v_xor_b32 v66, s68, v66
  v_xor_b32 v67, s69, v67
  s_mov_b32 exec_hi, -1
  v_or3_b32 v8, v8, v64, v65
  v_or3_b32 v8, v8, v66, v67
  v_and_b32 v8, 0xff, v8
  v_cmp_ne_u32 vcc, 0, v8
  v_pk_add_f32 v[36:37], v[36:37], v[64:65]
  v_pk_add_f32 v[38:39], v[38:39], v[66:67]
  s_cmp_eq_u64 vcc, 0
  s_cbranch_scc1 L_f_got
  s_add_u32 s34, s34, 1
  s_cmp_lt_u32 s34, 200000
  s_cbranch_scc1 L_f_loop
L_f_got:
  v_pk_add_f32 v[28:29], v[28:29], v[36:37]
  v_pk_add_f32 v[30:31], v[30:31], v[38:39]
  s_nop 1
  v_permlane32_swap_b32 v28, v30
  v_permlane32_swap_b32 v29, v31
  v_add_f32 v9, v28, v30
  v_add_f32 v10, v29, v31
  s_nop 1
  v_permlane16_swap_b32 v9, v10
  v_add_f32 v9, v9, v10
  s_nop 1
  v_add_f32_dpp v9, v9, v9 row_ror:8 row_mask:0xf bank_mask:0xf
  v_cvt_pk_bf16_f32 v9, v9, v9
  v_and_b32 v9, 0xffff0000, v9
  v_mul_f32 v9, v9, v25
  v_cvt_pk_bf16_f32 v9, v9, v9
  v_and_b32 v9, 0xffff0000, v9
  v_add_f32 v9, v9, v26
  v_cvt_pk_bf16_f32 v9, v9, v9
  s_mov_b32 exec_lo, 0x00ff00ff
  s_mov_b32 exec_hi, 0x00ff00ff
  buffer_store_short v9, v7, s[12:15], s30 offen
  s_endpgm
L_end:
  s_endpgm
.section .rodata,"a"
.p2align 6
.amdhsa_kernel adaLN_cond__gqa_block_cached__swiglu_ffn__decode_kernel
  .amdhsa_next_free_vgpr 168
  .amdhsa_next_free_sgpr 102
  .amdhsa_accum_offset 168
  .amdhsa_group_segment_fixed_size 0
  .amdhsa_kernarg_size 112
  .amdhsa_user_sgpr_count 2
  .amdhsa_user_sgpr_kernarg_segment_ptr 1
  .amdhsa_system_sgpr_workgroup_id_x 1
  .amdhsa_float_denorm_mode_32 3
.end_amdhsa_kernel
```
